```python
import torch

def _softmax(x, axis=-1):
    return torch.softmax(x, dim=axis)
def _gelu(x):
    return torch.nn.functional.gelu(x, approximate="tanh")
def _silu(x):
    return torch.nn.functional.silu(x)
def _sigmoid(x):
    return torch.sigmoid(x)
def _layernorm(x, axis=-1, eps=1e-5):
    m = x.mean(dim=axis, keepdim=True)
    v = x.var(dim=axis, keepdim=True, unbiased=False)
    return (x - m) / torch.sqrt(v + eps)
def _scatter_add(tgt, idx, src, axis=0):
    return tgt.clone().index_add_(axis, idx, src)
def _segment_sum(src, seg, n):
    out = torch.zeros((n,) + src.shape[1:], dtype=src.dtype)
    return out.index_add_(0, seg, src)
def _pad(x, pw):
    flat = tuple(v for pair in reversed(pw) for v in pair)
    return torch.nn.functional.pad(x, flat)

kernel_name = 'standalone__mha_softmax__near_ridge'

def setup_inputs():

    _w = (lambda a: (lambda t: t.to(torch.bfloat16) if t.is_floating_point() else t)(torch.as_tensor(a)))
    B, H, Sq, Sk, D = 8, 16, 384, 1024, 256
    return {
        "q": _w((lambda *s: torch.randn(*s, dtype=torch.bfloat16) * 0.8)(B, H, Sq, D)),
        "k": _w((lambda *s: torch.randn(*s, dtype=torch.bfloat16) * 0.8)(B, H, Sk, D)),
        "v": _w((lambda *s: torch.randn(*s, dtype=torch.bfloat16) * 0.05)(B, H, Sk, D)),
    }

def reference(q, k, v):
    scale = q.shape[-1] ** -0.5
    scores = torch.einsum("bhqd,bhkd->bhqk", q, k) * scale
    p = _softmax(scores, axis=-1)
    return torch.einsum("bhqk,bhkd->bhqd", p, v)
```

```asm
; @launch grid=(256,1,1) block=(256,1,1) lds=131072
.amdgcn_target "amdgcn-amd-amdhsa--gfx950"
.text
.globl standalone__mha_softmax__near_ridge_kernel
.p2align 8
.type standalone__mha_softmax__near_ridge_kernel,@function
standalone__mha_softmax__near_ridge_kernel:
    s_cmp_ge_u32 s2, 256
    s_cbranch_scc1 L_end
    s_load_dwordx4 s[28:31], s[0:1], 0
    s_load_dwordx4 s[32:35], s[0:1], 16
    v_and_b32 v1, 63, v0
    v_lshrrev_b32 v2, 6, v0
    s_nop 0
    v_readfirstlane_b32 s20, v2
    s_lshr_b32 s36, s2, 4
    s_lshl_b32 s36, s36, 3
    s_and_b32 s37, s2, 7
    s_or_b32 s36, s36, s37
    s_lshr_b32 s37, s2, 3
    s_and_b32 s37, s37, 1
    s_mov_b32 s21, 0x3db8aa3b
    s_mov_b32 s22, 0x47800000
    s_lshl_b32 s23, s20, 12
    s_waitcnt lgkmcnt(0)
    s_mul_i32 s38, s36, 196608
    s_add_u32 s4, s28, s38
    s_addc_u32 s5, s29, 0
    s_and_b32 s5, s5, 0xffff
    s_mov_b32 s6, 196608
    s_mov_b32 s7, 0x00020000
    s_add_u32 s16, s34, s38
    s_addc_u32 s17, s35, 0
    s_and_b32 s17, s17, 0xffff
    s_mov_b32 s18, 196608
    s_mov_b32 s19, 0x00020000
    s_mul_i32 s38, s36, 524288
    s_add_u32 s8, s30, s38
    s_addc_u32 s9, s31, 0
    s_and_b32 s9, s9, 0xffff
    s_mov_b32 s10, 524288
    s_mov_b32 s11, 0x00020000
    s_add_u32 s12, s32, s38
    s_addc_u32 s13, s33, 0
    s_and_b32 s13, s13, 0xffff
    s_mov_b32 s14, 524288
    s_mov_b32 s15, 0x00020000
    v_and_b32 v2, 15, v1
    v_lshrrev_b32 v3, 4, v1
    v_lshrrev_b32 v4, 5, v1
    v_and_b32 v7, 31, v1
    s_and_b32 s38, s20, 1
    s_lshl_b32 s38, s38, 3
    v_add_u32 v8, 0, v4
    v_or_b32 v8, s38, v8
    v_xor_b32 v8, v8, v7
    v_lshlrev_b32 v8, 4, v8
    v_lshl_add_u32 v234, v4, 9, v8
    v_add_u32 v8, 0, v4
    v_lshlrev_b32 v8, 1, v8
    v_xor_b32 v8, v8, v7
    v_lshlrev_b32 v8, 4, v8
    v_lshl_add_u32 v238, v4, 9, v8
    v_add_u32 v8, 2, v4
    v_or_b32 v8, s38, v8
    v_xor_b32 v8, v8, v7
    v_lshlrev_b32 v8, 4, v8
    v_lshl_add_u32 v235, v4, 9, v8
    v_add_u32 v8, 2, v4
    v_lshlrev_b32 v8, 1, v8
    v_xor_b32 v8, v8, v7
    v_lshlrev_b32 v8, 4, v8
    v_lshl_add_u32 v239, v4, 9, v8
    v_add_u32 v8, 4, v4
    v_or_b32 v8, s38, v8
    v_xor_b32 v8, v8, v7
    v_lshlrev_b32 v8, 4, v8
    v_lshl_add_u32 v236, v4, 9, v8
    v_add_u32 v8, 4, v4
    v_lshlrev_b32 v8, 1, v8
    v_xor_b32 v8, v8, v7
    v_lshlrev_b32 v8, 4, v8
    v_lshl_add_u32 v240, v4, 9, v8
    v_add_u32 v8, 6, v4
    v_or_b32 v8, s38, v8
    v_xor_b32 v8, v8, v7
    v_lshlrev_b32 v8, 4, v8
    v_lshl_add_u32 v237, v4, 9, v8
    v_add_u32 v8, 6, v4
    v_lshlrev_b32 v8, 1, v8
    v_xor_b32 v8, v8, v7
    v_lshlrev_b32 v8, 4, v8
    v_lshl_add_u32 v241, v4, 9, v8
    v_add_u32 v8, 0, v3
    v_xor_b32 v8, v8, v2
    v_lshlrev_b32 v8, 4, v8
    v_lshl_add_u32 v222, v2, 9, v8
    v_add_u32 v8, 4, v3
    v_xor_b32 v8, v8, v2
    v_lshlrev_b32 v8, 4, v8
    v_lshl_add_u32 v223, v2, 9, v8
    v_add_u32 v8, 8, v3
    v_xor_b32 v8, v8, v2
    v_lshlrev_b32 v8, 4, v8
    v_lshl_add_u32 v224, v2, 9, v8
    v_add_u32 v8, 12, v3
    v_xor_b32 v8, v8, v2
    v_lshlrev_b32 v8, 4, v8
    v_lshl_add_u32 v225, v2, 9, v8
    v_lshrrev_b32 v8, 2, v2
    v_lshl_add_u32 v8, v3, 2, v8
    v_and_b32 v9, 7, v8
    v_and_b32 v10, 3, v2
    v_lshrrev_b32 v11, 1, v10
    v_and_b32 v10, 1, v10
    v_lshlrev_b32 v10, 3, v10
    v_lshl_add_u32 v10, v8, 9, v10
    v_add_u32 v10, 65536, v10
    v_xor_b32 v12, 0, v9
    v_lshl_add_u32 v12, v12, 1, v11
    v_lshl_add_u32 v226, v12, 4, v10
    v_xor_b32 v12, 1, v9
    v_lshl_add_u32 v12, v12, 1, v11
    v_lshl_add_u32 v227, v12, 4, v10
    v_xor_b32 v12, 2, v9
    v_lshl_add_u32 v12, v12, 1, v11
    v_lshl_add_u32 v228, v12, 4, v10
    v_xor_b32 v12, 3, v9
    v_lshl_add_u32 v12, v12, 1, v11
    v_lshl_add_u32 v229, v12, 4, v10
    v_xor_b32 v12, 4, v9
    v_lshl_add_u32 v12, v12, 1, v11
    v_lshl_add_u32 v230, v12, 4, v10
    v_xor_b32 v12, 5, v9
    v_lshl_add_u32 v12, v12, 1, v11
    v_lshl_add_u32 v231, v12, 4, v10
    v_xor_b32 v12, 6, v9
    v_lshl_add_u32 v12, v12, 1, v11
    v_lshl_add_u32 v232, v12, 4, v10
    v_xor_b32 v12, 7, v9
    v_lshl_add_u32 v12, v12, 1, v11
    v_lshl_add_u32 v233, v12, 4, v10
    v_xor_b32 v5, 16, v1
    v_lshlrev_b32 v5, 2, v5
    v_xor_b32 v6, 32, v1
    v_lshlrev_b32 v6, 2, v6
    v_mov_b32 v212, 0x3f803f80
    v_mov_b32 v213, 0x3f803f80
    v_mov_b32 v214, 0x3f803f80
    v_mov_b32 v215, 0x3f803f80
    s_mov_b32 s24, s23
    s_mov_b32 s25, s23
    s_add_u32 m0, s23, 0
    s_nop 0
    buffer_load_dwordx4 v234, s[8:11], s24 offen offset:0 lds
    buffer_load_dwordx4 v235, s[8:11], s24 offen offset:1024 lds
    buffer_load_dwordx4 v236, s[8:11], s24 offen offset:2048 lds
    buffer_load_dwordx4 v237, s[8:11], s24 offen offset:3072 lds
    s_add_u32 s24, s24, 16384
    s_mul_i32 s38, s37, 192
    s_mul_i32 s39, s20, 48
    s_add_u32 s38, s38, s39
    s_lshl_b32 s38, s38, 9
    v_lshlrev_b32 v8, 4, v3
    v_lshl_add_u32 v8, v2, 9, v8
    v_add_u32 v9, 8192, v8
    v_add_u32 v10, 16384, v8
    buffer_load_dwordx4 v[16:19], v8, s[4:7], s38 offen offset:0
    buffer_load_dwordx4 v[20:23], v8, s[4:7], s38 offen offset:64
    buffer_load_dwordx4 v[24:27], v8, s[4:7], s38 offen offset:128
    buffer_load_dwordx4 v[28:31], v8, s[4:7], s38 offen offset:192
    buffer_load_dwordx4 v[32:35], v8, s[4:7], s38 offen offset:256
    buffer_load_dwordx4 v[36:39], v8, s[4:7], s38 offen offset:320
    buffer_load_dwordx4 v[40:43], v8, s[4:7], s38 offen offset:384
    buffer_load_dwordx4 v[44:47], v8, s[4:7], s38 offen offset:448
    buffer_load_dwordx4 v[48:51], v9, s[4:7], s38 offen offset:0
    buffer_load_dwordx4 v[52:55], v9, s[4:7], s38 offen offset:64
    buffer_load_dwordx4 v[56:59], v9, s[4:7], s38 offen offset:128
    buffer_load_dwordx4 v[60:63], v9, s[4:7], s38 offen offset:192
    buffer_load_dwordx4 v[64:67], v9, s[4:7], s38 offen offset:256
    buffer_load_dwordx4 v[68:71], v9, s[4:7], s38 offen offset:320
    buffer_load_dwordx4 v[72:75], v9, s[4:7], s38 offen offset:384
    buffer_load_dwordx4 v[76:79], v9, s[4:7], s38 offen offset:448
    buffer_load_dwordx4 v[80:83], v10, s[4:7], s38 offen offset:0
    buffer_load_dwordx4 v[84:87], v10, s[4:7], s38 offen offset:64
    buffer_load_dwordx4 v[88:91], v10, s[4:7], s38 offen offset:128
    buffer_load_dwordx4 v[92:95], v10, s[4:7], s38 offen offset:192
    buffer_load_dwordx4 v[96:99], v10, s[4:7], s38 offen offset:256
    buffer_load_dwordx4 v[100:103], v10, s[4:7], s38 offen offset:320
    buffer_load_dwordx4 v[104:107], v10, s[4:7], s38 offen offset:384
    buffer_load_dwordx4 v[108:111], v10, s[4:7], s38 offen offset:448
    s_add_u32 m0, s23, 16384
    s_nop 0
    buffer_load_dwordx4 v234, s[8:11], s24 offen offset:0 lds
    buffer_load_dwordx4 v235, s[8:11], s24 offen offset:1024 lds
    buffer_load_dwordx4 v236, s[8:11], s24 offen offset:2048 lds
    buffer_load_dwordx4 v237, s[8:11], s24 offen offset:3072 lds
    s_add_u32 s24, s24, 16384
    s_add_u32 m0, s23, 65536
    s_nop 0
    buffer_load_dwordx4 v238, s[12:15], s25 offen offset:0 lds
    buffer_load_dwordx4 v239, s[12:15], s25 offen offset:1024 lds
    buffer_load_dwordx4 v240, s[12:15], s25 offen offset:2048 lds
    buffer_load_dwordx4 v241, s[12:15], s25 offen offset:3072 lds
    s_add_u32 s25, s25, 16384
    s_add_u32 m0, s23, 32768
    s_nop 0
    buffer_load_dwordx4 v234, s[8:11], s24 offen offset:0 lds
    buffer_load_dwordx4 v235, s[8:11], s24 offen offset:1024 lds
    buffer_load_dwordx4 v236, s[8:11], s24 offen offset:2048 lds
    buffer_load_dwordx4 v237, s[8:11], s24 offen offset:3072 lds
    s_add_u32 s24, s24, 16384
    s_add_u32 m0, s23, 81920
    s_nop 0
    buffer_load_dwordx4 v238, s[12:15], s25 offen offset:0 lds
    buffer_load_dwordx4 v239, s[12:15], s25 offen offset:1024 lds
    buffer_load_dwordx4 v240, s[12:15], s25 offen offset:2048 lds
    buffer_load_dwordx4 v241, s[12:15], s25 offen offset:3072 lds
    s_add_u32 s25, s25, 16384
    s_add_u32 m0, s23, 49152
    s_nop 0
    buffer_load_dwordx4 v234, s[8:11], s24 offen offset:0 lds
    buffer_load_dwordx4 v235, s[8:11], s24 offen offset:1024 lds
    buffer_load_dwordx4 v236, s[8:11], s24 offen offset:2048 lds
    buffer_load_dwordx4 v237, s[8:11], s24 offen offset:3072 lds
    s_add_u32 s24, s24, 16384
    s_add_u32 m0, s23, 98304
    s_nop 0
    buffer_load_dwordx4 v238, s[12:15], s25 offen offset:0 lds
    buffer_load_dwordx4 v239, s[12:15], s25 offen offset:1024 lds
    buffer_load_dwordx4 v240, s[12:15], s25 offen offset:2048 lds
    buffer_load_dwordx4 v241, s[12:15], s25 offen offset:3072 lds
    s_add_u32 s25, s25, 16384
    v_accvgpr_write_b32 a0, 0
    v_accvgpr_write_b32 a1, 0
    v_accvgpr_write_b32 a2, 0
    v_accvgpr_write_b32 a3, 0
    v_accvgpr_write_b32 a4, 0
    v_accvgpr_write_b32 a5, 0
    v_accvgpr_write_b32 a6, 0
    v_accvgpr_write_b32 a7, 0
    v_accvgpr_write_b32 a8, 0
    v_accvgpr_write_b32 a9, 0
    v_accvgpr_write_b32 a10, 0
    v_accvgpr_write_b32 a11, 0
    v_accvgpr_write_b32 a12, 0
    v_accvgpr_write_b32 a13, 0
    v_accvgpr_write_b32 a14, 0
    v_accvgpr_write_b32 a15, 0
    v_accvgpr_write_b32 a16, 0
    v_accvgpr_write_b32 a17, 0
    v_accvgpr_write_b32 a18, 0
    v_accvgpr_write_b32 a19, 0
    v_accvgpr_write_b32 a20, 0
    v_accvgpr_write_b32 a21, 0
    v_accvgpr_write_b32 a22, 0
    v_accvgpr_write_b32 a23, 0
    v_accvgpr_write_b32 a24, 0
    v_accvgpr_write_b32 a25, 0
    v_accvgpr_write_b32 a26, 0
    v_accvgpr_write_b32 a27, 0
    v_accvgpr_write_b32 a28, 0
    v_accvgpr_write_b32 a29, 0
    v_accvgpr_write_b32 a30, 0
    v_accvgpr_write_b32 a31, 0
    v_accvgpr_write_b32 a32, 0
    v_accvgpr_write_b32 a33, 0
    v_accvgpr_write_b32 a34, 0
    v_accvgpr_write_b32 a35, 0
    v_accvgpr_write_b32 a36, 0
    v_accvgpr_write_b32 a37, 0
    v_accvgpr_write_b32 a38, 0
    v_accvgpr_write_b32 a39, 0
    v_accvgpr_write_b32 a40, 0
    v_accvgpr_write_b32 a41, 0
    v_accvgpr_write_b32 a42, 0
    v_accvgpr_write_b32 a43, 0
    v_accvgpr_write_b32 a44, 0
    v_accvgpr_write_b32 a45, 0
    v_accvgpr_write_b32 a46, 0
    v_accvgpr_write_b32 a47, 0
    v_accvgpr_write_b32 a48, 0
    v_accvgpr_write_b32 a49, 0
    v_accvgpr_write_b32 a50, 0
    v_accvgpr_write_b32 a51, 0
    v_accvgpr_write_b32 a52, 0
    v_accvgpr_write_b32 a53, 0
    v_accvgpr_write_b32 a54, 0
    v_accvgpr_write_b32 a55, 0
    v_accvgpr_write_b32 a56, 0
    v_accvgpr_write_b32 a57, 0
    v_accvgpr_write_b32 a58, 0
    v_accvgpr_write_b32 a59, 0
    v_accvgpr_write_b32 a60, 0
    v_accvgpr_write_b32 a61, 0
    v_accvgpr_write_b32 a62, 0
    v_accvgpr_write_b32 a63, 0
    v_accvgpr_write_b32 a64, 0
    v_accvgpr_write_b32 a65, 0
    v_accvgpr_write_b32 a66, 0
    v_accvgpr_write_b32 a67, 0
    v_accvgpr_write_b32 a68, 0
    v_accvgpr_write_b32 a69, 0
    v_accvgpr_write_b32 a70, 0
    v_accvgpr_write_b32 a71, 0
    v_accvgpr_write_b32 a72, 0
    v_accvgpr_write_b32 a73, 0
    v_accvgpr_write_b32 a74, 0
    v_accvgpr_write_b32 a75, 0
    v_accvgpr_write_b32 a76, 0
    v_accvgpr_write_b32 a77, 0
    v_accvgpr_write_b32 a78, 0
    v_accvgpr_write_b32 a79, 0
    v_accvgpr_write_b32 a80, 0
    v_accvgpr_write_b32 a81, 0
    v_accvgpr_write_b32 a82, 0
    v_accvgpr_write_b32 a83, 0
    v_accvgpr_write_b32 a84, 0
    v_accvgpr_write_b32 a85, 0
    v_accvgpr_write_b32 a86, 0
    v_accvgpr_write_b32 a87, 0
    v_accvgpr_write_b32 a88, 0
    v_accvgpr_write_b32 a89, 0
    v_accvgpr_write_b32 a90, 0
    v_accvgpr_write_b32 a91, 0
    v_accvgpr_write_b32 a92, 0
    v_accvgpr_write_b32 a93, 0
    v_accvgpr_write_b32 a94, 0
    v_accvgpr_write_b32 a95, 0
    v_accvgpr_write_b32 a96, 0
    v_accvgpr_write_b32 a97, 0
    v_accvgpr_write_b32 a98, 0
    v_accvgpr_write_b32 a99, 0
    v_accvgpr_write_b32 a100, 0
    v_accvgpr_write_b32 a101, 0
    v_accvgpr_write_b32 a102, 0
    v_accvgpr_write_b32 a103, 0
    v_accvgpr_write_b32 a104, 0
    v_accvgpr_write_b32 a105, 0
    v_accvgpr_write_b32 a106, 0
    v_accvgpr_write_b32 a107, 0
    v_accvgpr_write_b32 a108, 0
    v_accvgpr_write_b32 a109, 0
    v_accvgpr_write_b32 a110, 0
    v_accvgpr_write_b32 a111, 0
    v_accvgpr_write_b32 a112, 0
    v_accvgpr_write_b32 a113, 0
    v_accvgpr_write_b32 a114, 0
    v_accvgpr_write_b32 a115, 0
    v_accvgpr_write_b32 a116, 0
    v_accvgpr_write_b32 a117, 0
    v_accvgpr_write_b32 a118, 0
    v_accvgpr_write_b32 a119, 0
    v_accvgpr_write_b32 a120, 0
    v_accvgpr_write_b32 a121, 0
    v_accvgpr_write_b32 a122, 0
    v_accvgpr_write_b32 a123, 0
    v_accvgpr_write_b32 a124, 0
    v_accvgpr_write_b32 a125, 0
    v_accvgpr_write_b32 a126, 0
    v_accvgpr_write_b32 a127, 0
    v_accvgpr_write_b32 a128, 0
    v_accvgpr_write_b32 a129, 0
    v_accvgpr_write_b32 a130, 0
    v_accvgpr_write_b32 a131, 0
    v_accvgpr_write_b32 a132, 0
    v_accvgpr_write_b32 a133, 0
    v_accvgpr_write_b32 a134, 0
    v_accvgpr_write_b32 a135, 0
    v_accvgpr_write_b32 a136, 0
    v_accvgpr_write_b32 a137, 0
    v_accvgpr_write_b32 a138, 0
    v_accvgpr_write_b32 a139, 0
    v_accvgpr_write_b32 a140, 0
    v_accvgpr_write_b32 a141, 0
    v_accvgpr_write_b32 a142, 0
    v_accvgpr_write_b32 a143, 0
    v_accvgpr_write_b32 a144, 0
    v_accvgpr_write_b32 a145, 0
    v_accvgpr_write_b32 a146, 0
    v_accvgpr_write_b32 a147, 0
    v_accvgpr_write_b32 a148, 0
    v_accvgpr_write_b32 a149, 0
    v_accvgpr_write_b32 a150, 0
    v_accvgpr_write_b32 a151, 0
    v_accvgpr_write_b32 a152, 0
    v_accvgpr_write_b32 a153, 0
    v_accvgpr_write_b32 a154, 0
    v_accvgpr_write_b32 a155, 0
    v_accvgpr_write_b32 a156, 0
    v_accvgpr_write_b32 a157, 0
    v_accvgpr_write_b32 a158, 0
    v_accvgpr_write_b32 a159, 0
    v_accvgpr_write_b32 a160, 0
    v_accvgpr_write_b32 a161, 0
    v_accvgpr_write_b32 a162, 0
    v_accvgpr_write_b32 a163, 0
    v_accvgpr_write_b32 a164, 0
    v_accvgpr_write_b32 a165, 0
    v_accvgpr_write_b32 a166, 0
    v_accvgpr_write_b32 a167, 0
    v_accvgpr_write_b32 a168, 0
    v_accvgpr_write_b32 a169, 0
    v_accvgpr_write_b32 a170, 0
    v_accvgpr_write_b32 a171, 0
    v_accvgpr_write_b32 a172, 0
    v_accvgpr_write_b32 a173, 0
    v_accvgpr_write_b32 a174, 0
    v_accvgpr_write_b32 a175, 0
    v_accvgpr_write_b32 a176, 0
    v_accvgpr_write_b32 a177, 0
    v_accvgpr_write_b32 a178, 0
    v_accvgpr_write_b32 a179, 0
    v_accvgpr_write_b32 a180, 0
    v_accvgpr_write_b32 a181, 0
    v_accvgpr_write_b32 a182, 0
    v_accvgpr_write_b32 a183, 0
    v_accvgpr_write_b32 a184, 0
    v_accvgpr_write_b32 a185, 0
    v_accvgpr_write_b32 a186, 0
    v_accvgpr_write_b32 a187, 0
    v_accvgpr_write_b32 a188, 0
    v_accvgpr_write_b32 a189, 0
    v_accvgpr_write_b32 a190, 0
    v_accvgpr_write_b32 a191, 0
    v_mov_b32 v219, 0
    v_mov_b32 v220, 0
    v_mov_b32 v221, 0
    s_waitcnt vmcnt(24)
    s_barrier
    ds_read_b128 a[192:195], v222 offset:0
    ds_read_b128 a[196:199], v223 offset:0
    ds_read_b128 a[200:203], v224 offset:0
    ds_read_b128 a[204:207], v225 offset:0
    s_waitcnt lgkmcnt(3)
    v_mfma_f32_16x16x32_bf16 v[112:115], a[192:195], v[16:19], 0
    ds_read_b128 a[208:211], v222 offset:256
    v_mfma_f32_16x16x32_bf16 v[120:123], a[192:195], v[48:51], 0
    v_mfma_f32_16x16x32_bf16 v[128:131], a[192:195], v[80:83], 0
    s_waitcnt lgkmcnt(3)
    v_mfma_f32_16x16x32_bf16 v[112:115], a[196:199], v[20:23], v[112:115]
    ds_read_b128 a[212:215], v223 offset:256
    v_mfma_f32_16x16x32_bf16 v[120:123], a[196:199], v[52:55], v[120:123]
    v_mfma_f32_16x16x32_bf16 v[128:131], a[196:199], v[84:87], v[128:131]
    s_waitcnt lgkmcnt(3)
    v_mfma_f32_16x16x32_bf16 v[112:115], a[200:203], v[24:27], v[112:115]
    ds_read_b128 a[216:219], v224 offset:256
    v_mfma_f32_16x16x32_bf16 v[120:123], a[200:203], v[56:59], v[120:123]
    v_mfma_f32_16x16x32_bf16 v[128:131], a[200:203], v[88:91], v[128:131]
    s_waitcnt lgkmcnt(3)
    v_mfma_f32_16x16x32_bf16 v[112:115], a[204:207], v[28:31], v[112:115]
    ds_read_b128 a[220:223], v225 offset:256
    v_mfma_f32_16x16x32_bf16 v[120:123], a[204:207], v[60:63], v[120:123]
    v_mfma_f32_16x16x32_bf16 v[128:131], a[204:207], v[92:95], v[128:131]
    s_waitcnt lgkmcnt(3)
    v_mfma_f32_16x16x32_bf16 v[112:115], a[208:211], v[32:35], v[112:115]
    ds_read_b128 a[192:195], v222 offset:8192
    v_mfma_f32_16x16x32_bf16 v[120:123], a[208:211], v[64:67], v[120:123]
    v_mfma_f32_16x16x32_bf16 v[128:131], a[208:211], v[96:99], v[128:131]
    s_waitcnt lgkmcnt(3)
    v_mfma_f32_16x16x32_bf16 v[112:115], a[212:215], v[36:39], v[112:115]
    ds_read_b128 a[196:199], v223 offset:8192
    v_mfma_f32_16x16x32_bf16 v[120:123], a[212:215], v[68:71], v[120:123]
    v_mfma_f32_16x16x32_bf16 v[128:131], a[212:215], v[100:103], v[128:131]
    s_waitcnt lgkmcnt(3)
    v_mfma_f32_16x16x32_bf16 v[112:115], a[216:219], v[40:43], v[112:115]
    ds_read_b128 a[200:203], v224 offset:8192
    v_mfma_f32_16x16x32_bf16 v[120:123], a[216:219], v[72:75], v[120:123]
    v_mfma_f32_16x16x32_bf16 v[128:131], a[216:219], v[104:107], v[128:131]
    s_waitcnt lgkmcnt(3)
    v_mfma_f32_16x16x32_bf16 v[112:115], a[220:223], v[44:47], v[112:115]
    ds_read_b128 a[204:207], v225 offset:8192
    v_mfma_f32_16x16x32_bf16 v[120:123], a[220:223], v[76:79], v[120:123]
    v_mfma_f32_16x16x32_bf16 v[128:131], a[220:223], v[108:111], v[128:131]
    s_waitcnt lgkmcnt(3)
    v_mfma_f32_16x16x32_bf16 v[116:119], a[192:195], v[16:19], 0
    ds_read_b128 a[208:211], v222 offset:8448
    v_mfma_f32_16x16x32_bf16 v[124:127], a[192:195], v[48:51], 0
    v_mfma_f32_16x16x32_bf16 v[132:135], a[192:195], v[80:83], 0
    s_waitcnt lgkmcnt(3)
    v_mfma_f32_16x16x32_bf16 v[116:119], a[196:199], v[20:23], v[116:119]
    ds_read_b128 a[212:215], v223 offset:8448
    v_mfma_f32_16x16x32_bf16 v[124:127], a[196:199], v[52:55], v[124:127]
    v_mfma_f32_16x16x32_bf16 v[132:135], a[196:199], v[84:87], v[132:135]
    s_waitcnt lgkmcnt(3)
    v_mfma_f32_16x16x32_bf16 v[116:119], a[200:203], v[24:27], v[116:119]
    ds_read_b128 a[216:219], v224 offset:8448
    v_mfma_f32_16x16x32_bf16 v[124:127], a[200:203], v[56:59], v[124:127]
    v_mfma_f32_16x16x32_bf16 v[132:135], a[200:203], v[88:91], v[132:135]
    s_waitcnt lgkmcnt(3)
    v_mfma_f32_16x16x32_bf16 v[116:119], a[204:207], v[28:31], v[116:119]
    ds_read_b128 a[220:223], v225 offset:8448
    v_mfma_f32_16x16x32_bf16 v[124:127], a[204:207], v[60:63], v[124:127]
    v_mfma_f32_16x16x32_bf16 v[132:135], a[204:207], v[92:95], v[132:135]
    s_waitcnt lgkmcnt(3)
    v_mfma_f32_16x16x32_bf16 v[116:119], a[208:211], v[32:35], v[116:119]
    v_mfma_f32_16x16x32_bf16 v[124:127], a[208:211], v[64:67], v[124:127]
    v_mfma_f32_16x16x32_bf16 v[132:135], a[208:211], v[96:99], v[132:135]
    s_waitcnt lgkmcnt(2)
    v_mfma_f32_16x16x32_bf16 v[116:119], a[212:215], v[36:39], v[116:119]
    v_mfma_f32_16x16x32_bf16 v[124:127], a[212:215], v[68:71], v[124:127]
    v_mfma_f32_16x16x32_bf16 v[132:135], a[212:215], v[100:103], v[132:135]
    s_waitcnt lgkmcnt(1)
    v_mfma_f32_16x16x32_bf16 v[116:119], a[216:219], v[40:43], v[116:119]
    v_mfma_f32_16x16x32_bf16 v[124:127], a[216:219], v[72:75], v[124:127]
    v_mfma_f32_16x16x32_bf16 v[132:135], a[216:219], v[104:107], v[132:135]
    s_waitcnt lgkmcnt(0)
    v_mfma_f32_16x16x32_bf16 v[116:119], a[220:223], v[44:47], v[116:119]
    v_mfma_f32_16x16x32_bf16 v[124:127], a[220:223], v[76:79], v[124:127]
    v_mfma_f32_16x16x32_bf16 v[132:135], a[220:223], v[108:111], v[132:135]
    v_max3_f32 v250, v112, v113, v114
    s_nop 4
    v_max3_f32 v250, v250, v115, v116
    v_max3_f32 v250, v250, v117, v118
    v_max_f32 v250, v250, v119
    v_max3_f32 v251, v120, v121, v122
    v_max3_f32 v251, v251, v123, v124
    v_max3_f32 v251, v251, v125, v126
    v_max_f32 v251, v251, v127
    v_max3_f32 v252, v128, v129, v130
    v_max3_f32 v252, v252, v131, v132
    v_max3_f32 v252, v252, v133, v134
    v_max_f32 v252, v252, v135
    ds_bpermute_b32 v2, v5, v250
    ds_bpermute_b32 v3, v5, v251
    ds_bpermute_b32 v4, v5, v252
    s_waitcnt lgkmcnt(2)
    v_max_f32 v250, v250, v2
    s_waitcnt lgkmcnt(1)
    v_max_f32 v251, v251, v3
    s_waitcnt lgkmcnt(0)
    v_max_f32 v252, v252, v4
    ds_bpermute_b32 v2, v6, v250
    ds_bpermute_b32 v3, v6, v251
    ds_bpermute_b32 v4, v6, v252
    s_waitcnt lgkmcnt(2)
    v_max_f32 v250, v250, v2
    s_waitcnt lgkmcnt(1)
    v_max_f32 v251, v251, v3
    s_waitcnt lgkmcnt(0)
    v_max_f32 v252, v252, v4
    v_mul_f32 v250, s21, v250
    v_mul_f32 v251, s21, v251
    v_mul_f32 v252, s21, v252
    v_mov_b32 v216, v250
    v_mov_b32 v217, v251
    v_mov_b32 v218, v252
    v_fma_f32 v184, v112, s21, -v216
    v_exp_f32 v184, v184
    v_fma_f32 v185, v113, s21, -v216
    v_exp_f32 v185, v185
    v_fma_f32 v186, v114, s21, -v216
    v_exp_f32 v186, v186
    v_fma_f32 v187, v115, s21, -v216
    v_exp_f32 v187, v187
    v_fma_f32 v188, v120, s21, -v217
    v_exp_f32 v188, v188
    v_fma_f32 v189, v121, s21, -v217
    v_exp_f32 v189, v189
    v_fma_f32 v190, v122, s21, -v217
    v_exp_f32 v190, v190
    v_fma_f32 v191, v123, s21, -v217
    v_exp_f32 v191, v191
    v_fma_f32 v192, v116, s21, -v216
    v_exp_f32 v192, v192
    v_fma_f32 v193, v117, s21, -v216
    v_exp_f32 v193, v193
    v_fma_f32 v194, v118, s21, -v216
    v_exp_f32 v194, v194
    v_fma_f32 v195, v119, s21, -v216
    v_exp_f32 v195, v195
    v_fma_f32 v196, v124, s21, -v217
    v_exp_f32 v196, v196
    v_fma_f32 v197, v125, s21, -v217
    v_exp_f32 v197, v197
    v_fma_f32 v198, v126, s21, -v217
    v_exp_f32 v198, v198
    v_fma_f32 v199, v127, s21, -v217
    v_exp_f32 v199, v199
    s_waitcnt vmcnt(16)
    s_barrier
    s_add_u32 m0, s23, 0
    s_nop 0
    buffer_load_dwordx4 v234, s[8:11], s24 offen offset:0 lds
    buffer_load_dwordx4 v235, s[8:11], s24 offen offset:1024 lds
    buffer_load_dwordx4 v236, s[8:11], s24 offen offset:2048 lds
    buffer_load_dwordx4 v237, s[8:11], s24 offen offset:3072 lds
    s_add_u32 s24, s24, 16384
    ds_read_b128 a[192:195], v222 offset:16384
    ds_read_b128 a[196:199], v223 offset:16384
    ds_read_b128 a[200:203], v224 offset:16384
    s_getpc_b64 s[40:41]
L_pc0:
    s_add_u32 s40, s40, L_rare0-L_pc0
    s_addc_u32 s41, s41, 0
    s_getpc_b64 s[42:43]
L_pc1:
    s_add_u32 s42, s42, L_rare1-L_pc1
    s_addc_u32 s43, s43, 0
    s_mov_b32 s26, 0
L_loop:
    s_waitcnt lgkmcnt(2)
    v_mfma_f32_16x16x32_bf16 v[136:139], a[192:195], v[16:19], 0
    ds_read_b128 a[204:207], v225 offset:16384
    v_fma_f32 v242, v128, s21, -v218
    v_mfma_f32_16x16x32_bf16 v[144:147], a[192:195], v[48:51], 0
    v_exp_f32 v242, v242
    v_mfma_f32_16x16x32_bf16 v[152:155], a[192:195], v[80:83], 0
    v_fma_f32 v243, v129, s21, -v218
    s_waitcnt lgkmcnt(2)
    v_mfma_f32_16x16x32_bf16 v[136:139], a[196:199], v[20:23], v[136:139]
    ds_read_b128 a[208:211], v222 offset:16640
    v_mfma_f32_16x16x32_bf16 v[144:147], a[196:199], v[52:55], v[144:147]
    v_exp_f32 v243, v243
    v_mfma_f32_16x16x32_bf16 v[152:155], a[196:199], v[84:87], v[152:155]
    v_fma_f32 v244, v130, s21, -v218
    s_waitcnt lgkmcnt(2)
    v_mfma_f32_16x16x32_bf16 v[136:139], a[200:203], v[24:27], v[136:139]
    ds_read_b128 a[212:215], v223 offset:16640
    v_mfma_f32_16x16x32_bf16 v[144:147], a[200:203], v[56:59], v[144:147]
    v_exp_f32 v244, v244
    v_mfma_f32_16x16x32_bf16 v[152:155], a[200:203], v[88:91], v[152:155]
    v_fma_f32 v245, v131, s21, -v218
    s_waitcnt lgkmcnt(2)
    v_mfma_f32_16x16x32_bf16 v[136:139], a[204:207], v[28:31], v[136:139]
    ds_read_b128 a[216:219], v224 offset:16640
    v_mfma_f32_16x16x32_bf16 v[144:147], a[204:207], v[60:63], v[144:147]
    v_exp_f32 v245, v245
    v_mfma_f32_16x16x32_bf16 v[152:155], a[204:207], v[92:95], v[152:155]
    v_fma_f32 v246, v132, s21, -v218
    s_waitcnt lgkmcnt(2)
    v_mfma_f32_16x16x32_bf16 v[136:139], a[208:211], v[32:35], v[136:139]
    ds_read_b128 a[220:223], v225 offset:16640
    v_mfma_f32_16x16x32_bf16 v[144:147], a[208:211], v[64:67], v[144:147]
    v_exp_f32 v246, v246
    v_mfma_f32_16x16x32_bf16 v[152:155], a[208:211], v[96:99], v[152:155]
    v_fma_f32 v247, v133, s21, -v218
    s_waitcnt lgkmcnt(2)
    v_mfma_f32_16x16x32_bf16 v[136:139], a[212:215], v[36:39], v[136:139]
    ds_read_b128 a[192:195], v222 offset:24576
    v_mfma_f32_16x16x32_bf16 v[144:147], a[212:215], v[68:71], v[144:147]
    v_exp_f32 v247, v247
    v_mfma_f32_16x16x32_bf16 v[152:155], a[212:215], v[100:103], v[152:155]
    v_fma_f32 v248, v134, s21, -v218
    s_waitcnt lgkmcnt(2)
    v_mfma_f32_16x16x32_bf16 v[136:139], a[216:219], v[40:43], v[136:139]
    ds_read_b128 a[196:199], v223 offset:24576
    v_mfma_f32_16x16x32_bf16 v[144:147], a[216:219], v[72:75], v[144:147]
    v_exp_f32 v248, v248
    v_mfma_f32_16x16x32_bf16 v[152:155], a[216:219], v[104:107], v[152:155]
    v_fma_f32 v249, v135, s21, -v218
    s_waitcnt lgkmcnt(2)
    v_mfma_f32_16x16x32_bf16 v[136:139], a[220:223], v[44:47], v[136:139]
    ds_read_b128 a[200:203], v224 offset:24576
    v_mfma_f32_16x16x32_bf16 v[144:147], a[220:223], v[76:79], v[144:147]
    v_exp_f32 v249, v249
    v_mfma_f32_16x16x32_bf16 v[152:155], a[220:223], v[108:111], v[152:155]
    v_cvt_pk_bf16_f32 v160, v184, v185
    v_cvt_pk_bf16_f32 v161, v186, v187
    s_waitcnt lgkmcnt(2)
    v_mfma_f32_16x16x32_bf16 v[140:143], a[192:195], v[16:19], 0
    ds_read_b128 a[204:207], v225 offset:24576
    v_cvt_pk_bf16_f32 v164, v188, v189
    v_mfma_f32_16x16x32_bf16 v[148:151], a[192:195], v[48:51], 0
    v_cvt_pk_bf16_f32 v165, v190, v191
    v_cvt_pk_bf16_f32 v162, v192, v193
    v_mfma_f32_16x16x32_bf16 v[156:159], a[192:195], v[80:83], 0
    v_cvt_pk_bf16_f32 v163, v194, v195
    v_cvt_pk_bf16_f32 v166, v196, v197
    s_waitcnt lgkmcnt(2)
    v_mfma_f32_16x16x32_bf16 v[140:143], a[196:199], v[20:23], v[140:143]
    ds_read_b128 a[208:211], v222 offset:24832
    v_cvt_pk_bf16_f32 v167, v198, v199
    v_mfma_f32_16x16x32_bf16 v[148:151], a[196:199], v[52:55], v[148:151]
    v_cvt_pk_bf16_f32 v168, v242, v243
    v_cvt_pk_bf16_f32 v169, v244, v245
    v_mfma_f32_16x16x32_bf16 v[156:159], a[196:199], v[84:87], v[156:159]
    v_cvt_pk_bf16_f32 v170, v246, v247
    v_cvt_pk_bf16_f32 v171, v248, v249
    s_waitcnt lgkmcnt(2)
    v_mfma_f32_16x16x32_bf16 v[140:143], a[200:203], v[24:27], v[140:143]
    ds_read_b128 a[212:215], v223 offset:24832
    v_mfma_f32_16x16x32_bf16 v[148:151], a[200:203], v[56:59], v[148:151]
    v_mfma_f32_16x16x32_bf16 v[156:159], a[200:203], v[88:91], v[156:159]
    s_waitcnt lgkmcnt(2)
    v_mfma_f32_16x16x32_bf16 v[140:143], a[204:207], v[28:31], v[140:143]
    ds_read_b128 a[216:219], v224 offset:24832
    v_mfma_f32_16x16x32_bf16 v[148:151], a[204:207], v[60:63], v[148:151]
    v_mfma_f32_16x16x32_bf16 v[156:159], a[204:207], v[92:95], v[156:159]
    v_mfma_f32_16x16x32_bf16 v[200:203], v[212:215], v[160:163], 0
    ds_read_b128 a[220:223], v225 offset:24832
    ds_read_b64_tr_b16 a[224:225], v226 offset:0
    v_mfma_f32_16x16x32_bf16 v[204:207], v[212:215], v[164:167], 0
    ds_read_b64_tr_b16 a[226:227], v226 offset:8192
    ds_read_b64_tr_b16 a[228:229], v227 offset:0
    v_mfma_f32_16x16x32_bf16 v[208:211], v[212:215], v[168:171], 0
    ds_read_b64_tr_b16 a[230:231], v227 offset:8192
    ds_read_b64_tr_b16 a[232:233], v228 offset:0
    s_waitcnt lgkmcnt(8)
    v_mfma_f32_16x16x32_bf16 v[140:143], a[208:211], v[32:35], v[140:143]
    ds_read_b64_tr_b16 a[234:235], v228 offset:8192
    v_mfma_f32_16x16x32_bf16 v[148:151], a[208:211], v[64:67], v[148:151]
    v_mfma_f32_16x16x32_bf16 v[156:159], a[208:211], v[96:99], v[156:159]
    s_waitcnt lgkmcnt(8)
    v_mfma_f32_16x16x32_bf16 v[140:143], a[212:215], v[36:39], v[140:143]
    v_mfma_f32_16x16x32_bf16 v[148:151], a[212:215], v[68:71], v[148:151]
    v_mfma_f32_16x16x32_bf16 v[156:159], a[212:215], v[100:103], v[156:159]
    s_waitcnt lgkmcnt(7)
    v_mfma_f32_16x16x32_bf16 v[140:143], a[216:219], v[40:43], v[140:143]
    v_mfma_f32_16x16x32_bf16 v[148:151], a[216:219], v[72:75], v[148:151]
    v_mfma_f32_16x16x32_bf16 v[156:159], a[216:219], v[104:107], v[156:159]
    s_waitcnt lgkmcnt(6)
    v_mfma_f32_16x16x32_bf16 v[140:143], a[220:223], v[44:47], v[140:143]
    v_mfma_f32_16x16x32_bf16 v[148:151], a[220:223], v[76:79], v[148:151]
    v_mfma_f32_16x16x32_bf16 v[156:159], a[220:223], v[108:111], v[156:159]
    v_max3_f32 v250, v200, v204, v208
    v_cmp_nle_f32 vcc, v250, s22
    s_cbranch_vccz L_ok_0
    s_swappc_b64 s[44:45], s[40:41]
L_ok_0:
    v_add_f32 v219, v219, v200
    v_add_f32 v220, v220, v204
    v_add_f32 v221, v221, v208
    s_waitcnt vmcnt(8)
    s_barrier
    s_waitcnt lgkmcnt(4)
    v_mfma_f32_16x16x32_bf16 a[0:3], a[224:227], v[160:163], a[0:3]
    ds_read_b64_tr_b16 a[236:237], v229 offset:0
    ds_read_b64_tr_b16 a[238:239], v229 offset:8192
    v_mfma_f32_16x16x32_bf16 a[64:67], a[224:227], v[164:167], a[64:67]
    v_fma_f32 v184, v136, s21, -v216
    s_add_u32 m0, s23, 16384
    v_mfma_f32_16x16x32_bf16 a[128:131], a[224:227], v[168:171], a[128:131]
    v_exp_f32 v184, v184
    s_waitcnt lgkmcnt(4)
    v_mfma_f32_16x16x32_bf16 a[4:7], a[228:231], v[160:163], a[4:7]
    ds_read_b64_tr_b16 a[240:241], v230 offset:0
    ds_read_b64_tr_b16 a[242:243], v230 offset:8192
    v_mfma_f32_16x16x32_bf16 a[68:71], a[228:231], v[164:167], a[68:71]
    v_fma_f32 v185, v137, s21, -v216
    buffer_load_dwordx4 v234, s[8:11], s24 offen offset:0 lds
    v_mfma_f32_16x16x32_bf16 a[132:135], a[228:231], v[168:171], a[132:135]
    v_exp_f32 v185, v185
    s_waitcnt lgkmcnt(4)
    v_mfma_f32_16x16x32_bf16 a[8:11], a[232:235], v[160:163], a[8:11]
    ds_read_b64_tr_b16 a[244:245], v231 offset:0
    ds_read_b64_tr_b16 a[246:247], v231 offset:8192
    v_mfma_f32_16x16x32_bf16 a[72:75], a[232:235], v[164:167], a[72:75]
    v_fma_f32 v186, v138, s21, -v216
    buffer_load_dwordx4 v235, s[8:11], s24 offen offset:1024 lds
    v_mfma_f32_16x16x32_bf16 a[136:139], a[232:235], v[168:171], a[136:139]
    v_exp_f32 v186, v186
    s_waitcnt lgkmcnt(4)
    v_mfma_f32_16x16x32_bf16 a[12:15], a[236:239], v[160:163], a[12:15]
    ds_read_b64_tr_b16 a[248:249], v232 offset:0
    ds_read_b64_tr_b16 a[250:251], v232 offset:8192
    v_mfma_f32_16x16x32_bf16 a[76:79], a[236:239], v[164:167], a[76:79]
    v_fma_f32 v187, v139, s21, -v216
    buffer_load_dwordx4 v236, s[8:11], s24 offen offset:2048 lds
    v_mfma_f32_16x16x32_bf16 a[140:143], a[236:239], v[168:171], a[140:143]
    v_exp_f32 v187, v187
    s_waitcnt lgkmcnt(4)
    v_mfma_f32_16x16x32_bf16 a[16:19], a[240:243], v[160:163], a[16:19]
    ds_read_b64_tr_b16 a[252:253], v233 offset:0
    ds_read_b64_tr_b16 a[254:255], v233 offset:8192
    v_mfma_f32_16x16x32_bf16 a[80:83], a[240:243], v[164:167], a[80:83]
    v_fma_f32 v188, v144, s21, -v217
    buffer_load_dwordx4 v237, s[8:11], s24 offen offset:3072 lds
    v_mfma_f32_16x16x32_bf16 a[144:147], a[240:243], v[168:171], a[144:147]
    v_exp_f32 v188, v188
    s_waitcnt lgkmcnt(4)
    v_mfma_f32_16x16x32_bf16 a[20:23], a[244:247], v[160:163], a[20:23]
    ds_read_b64_tr_b16 a[224:225], v226 offset:256
    ds_read_b64_tr_b16 a[226:227], v226 offset:8448
    v_mfma_f32_16x16x32_bf16 a[84:87], a[244:247], v[164:167], a[84:87]
    v_fma_f32 v189, v145, s21, -v217
    s_add_u32 s24, s24, 16384
    v_mfma_f32_16x16x32_bf16 a[148:151], a[244:247], v[168:171], a[148:151]
    v_exp_f32 v189, v189
    s_waitcnt lgkmcnt(4)
    v_mfma_f32_16x16x32_bf16 a[24:27], a[248:251], v[160:163], a[24:27]
    ds_read_b64_tr_b16 a[228:229], v227 offset:256
    ds_read_b64_tr_b16 a[230:231], v227 offset:8448
    v_mfma_f32_16x16x32_bf16 a[88:91], a[248:251], v[164:167], a[88:91]
    v_fma_f32 v190, v146, s21, -v217
    s_add_u32 m0, s23, 114688
    v_mfma_f32_16x16x32_bf16 a[152:155], a[248:251], v[168:171], a[152:155]
    v_exp_f32 v190, v190
    s_waitcnt lgkmcnt(4)
    v_mfma_f32_16x16x32_bf16 a[28:31], a[252:255], v[160:163], a[28:31]
    ds_read_b64_tr_b16 a[232:233], v228 offset:256
    ds_read_b64_tr_b16 a[234:235], v228 offset:8448
    v_mfma_f32_16x16x32_bf16 a[92:95], a[252:255], v[164:167], a[92:95]
    v_fma_f32 v191, v147, s21, -v217
    buffer_load_dwordx4 v238, s[12:15], s25 offen offset:0 lds
    v_mfma_f32_16x16x32_bf16 a[156:159], a[252:255], v[168:171], a[156:159]
    v_exp_f32 v191, v191
    s_waitcnt lgkmcnt(4)
    v_mfma_f32_16x16x32_bf16 a[32:35], a[224:227], v[160:163], a[32:35]
    ds_read_b64_tr_b16 a[236:237], v229 offset:256
    ds_read_b64_tr_b16 a[238:239], v229 offset:8448
    v_mfma_f32_16x16x32_bf16 a[96:99], a[224:227], v[164:167], a[96:99]
    v_fma_f32 v192, v140, s21, -v216
    buffer_load_dwordx4 v239, s[12:15], s25 offen offset:1024 lds
    v_mfma_f32_16x16x32_bf16 a[160:163], a[224:227], v[168:171], a[160:163]
    v_exp_f32 v192, v192
    s_waitcnt lgkmcnt(4)
    v_mfma_f32_16x16x32_bf16 a[36:39], a[228:231], v[160:163], a[36:39]
    ds_read_b64_tr_b16 a[240:241], v230 offset:256
    ds_read_b64_tr_b16 a[242:243], v230 offset:8448
    v_mfma_f32_16x16x32_bf16 a[100:103], a[228:231], v[164:167], a[100:103]
    v_fma_f32 v193, v141, s21, -v216
    buffer_load_dwordx4 v240, s[12:15], s25 offen offset:2048 lds
    v_mfma_f32_16x16x32_bf16 a[164:167], a[228:231], v[168:171], a[164:167]
    v_exp_f32 v193, v193
    s_waitcnt lgkmcnt(4)
    v_mfma_f32_16x16x32_bf16 a[40:43], a[232:235], v[160:163], a[40:43]
    ds_read_b64_tr_b16 a[244:245], v231 offset:256
    ds_read_b64_tr_b16 a[246:247], v231 offset:8448
    v_mfma_f32_16x16x32_bf16 a[104:107], a[232:235], v[164:167], a[104:107]
    v_fma_f32 v194, v142, s21, -v216
    buffer_load_dwordx4 v241, s[12:15], s25 offen offset:3072 lds
    v_mfma_f32_16x16x32_bf16 a[168:171], a[232:235], v[168:171], a[168:171]
    v_exp_f32 v194, v194
    s_waitcnt lgkmcnt(4)
    v_mfma_f32_16x16x32_bf16 a[44:47], a[236:239], v[160:163], a[44:47]
    ds_read_b64_tr_b16 a[248:249], v232 offset:256
    ds_read_b64_tr_b16 a[250:251], v232 offset:8448
    v_mfma_f32_16x16x32_bf16 a[108:111], a[236:239], v[164:167], a[108:111]
    v_fma_f32 v195, v143, s21, -v216
    s_add_u32 s25, s25, 16384
    v_mfma_f32_16x16x32_bf16 a[172:175], a[236:239], v[168:171], a[172:175]
    v_exp_f32 v195, v195
    s_waitcnt lgkmcnt(4)
    v_mfma_f32_16x16x32_bf16 a[48:51], a[240:243], v[160:163], a[48:51]
    ds_read_b64_tr_b16 a[252:253], v233 offset:256
    ds_read_b64_tr_b16 a[254:255], v233 offset:8448
    v_mfma_f32_16x16x32_bf16 a[112:115], a[240:243], v[164:167], a[112:115]
    v_fma_f32 v196, v148, s21, -v217
    ds_read_b128 a[192:195], v222 offset:32768
    v_mfma_f32_16x16x32_bf16 a[176:179], a[240:243], v[168:171], a[176:179]
    v_exp_f32 v196, v196
    s_waitcnt lgkmcnt(5)
    v_mfma_f32_16x16x32_bf16 a[52:55], a[244:247], v[160:163], a[52:55]
    v_fma_f32 v197, v149, s21, -v217
    ds_read_b128 a[196:199], v223 offset:32768
    v_mfma_f32_16x16x32_bf16 a[116:119], a[244:247], v[164:167], a[116:119]
    v_exp_f32 v197, v197
    v_mfma_f32_16x16x32_bf16 a[180:183], a[244:247], v[168:171], a[180:183]
    v_fma_f32 v198, v150, s21, -v217
    ds_read_b128 a[200:203], v224 offset:32768
    s_waitcnt lgkmcnt(5)
    v_mfma_f32_16x16x32_bf16 a[56:59], a[248:251], v[160:163], a[56:59]
    v_exp_f32 v198, v198
    v_mfma_f32_16x16x32_bf16 a[120:123], a[248:251], v[164:167], a[120:123]
    v_fma_f32 v199, v151, s21, -v217
    v_mfma_f32_16x16x32_bf16 a[184:187], a[248:251], v[168:171], a[184:187]
    v_exp_f32 v199, v199
    s_waitcnt lgkmcnt(3)
    v_mfma_f32_16x16x32_bf16 a[60:63], a[252:255], v[160:163], a[60:63]
    v_mfma_f32_16x16x32_bf16 a[124:127], a[252:255], v[164:167], a[124:127]
    v_mfma_f32_16x16x32_bf16 a[188:191], a[252:255], v[168:171], a[188:191]
    s_waitcnt lgkmcnt(2)
    v_mfma_f32_16x16x32_bf16 v[112:115], a[192:195], v[16:19], 0
    ds_read_b128 a[204:207], v225 offset:32768
    v_fma_f32 v242, v152, s21, -v218
    v_mfma_f32_16x16x32_bf16 v[120:123], a[192:195], v[48:51], 0
    v_exp_f32 v242, v242
    v_mfma_f32_16x16x32_bf16 v[128:131], a[192:195], v[80:83], 0
    v_fma_f32 v243, v153, s21, -v218
    s_waitcnt lgkmcnt(2)
    v_mfma_f32_16x16x32_bf16 v[112:115], a[196:199], v[20:23], v[112:115]
    ds_read_b128 a[208:211], v222 offset:33024
    v_mfma_f32_16x16x32_bf16 v[120:123], a[196:199], v[52:55], v[120:123]
    v_exp_f32 v243, v243
    v_mfma_f32_16x16x32_bf16 v[128:131], a[196:199], v[84:87], v[128:131]
    v_fma_f32 v244, v154, s21, -v218
    s_waitcnt lgkmcnt(2)
    v_mfma_f32_16x16x32_bf16 v[112:115], a[200:203], v[24:27], v[112:115]
    ds_read_b128 a[212:215], v223 offset:33024
    v_mfma_f32_16x16x32_bf16 v[120:123], a[200:203], v[56:59], v[120:123]
    v_exp_f32 v244, v244
    v_mfma_f32_16x16x32_bf16 v[128:131], a[200:203], v[88:91], v[128:131]
    v_fma_f32 v245, v155, s21, -v218
    s_waitcnt lgkmcnt(2)
    v_mfma_f32_16x16x32_bf16 v[112:115], a[204:207], v[28:31], v[112:115]
    ds_read_b128 a[216:219], v224 offset:33024
    v_mfma_f32_16x16x32_bf16 v[120:123], a[204:207], v[60:63], v[120:123]
    v_exp_f32 v245, v245
    v_mfma_f32_16x16x32_bf16 v[128:131], a[204:207], v[92:95], v[128:131]
    v_fma_f32 v246, v156, s21, -v218
    s_waitcnt lgkmcnt(2)
    v_mfma_f32_16x16x32_bf16 v[112:115], a[208:211], v[32:35], v[112:115]
    ds_read_b128 a[220:223], v225 offset:33024
    v_mfma_f32_16x16x32_bf16 v[120:123], a[208:211], v[64:67], v[120:123]
    v_exp_f32 v246, v246
    v_mfma_f32_16x16x32_bf16 v[128:131], a[208:211], v[96:99], v[128:131]
    v_fma_f32 v247, v157, s21, -v218
    s_waitcnt lgkmcnt(2)
    v_mfma_f32_16x16x32_bf16 v[112:115], a[212:215], v[36:39], v[112:115]
    ds_read_b128 a[192:195], v222 offset:40960
    v_mfma_f32_16x16x32_bf16 v[120:123], a[212:215], v[68:71], v[120:123]
    v_exp_f32 v247, v247
    v_mfma_f32_16x16x32_bf16 v[128:131], a[212:215], v[100:103], v[128:131]
    v_fma_f32 v248, v158, s21, -v218
    s_waitcnt lgkmcnt(2)
    v_mfma_f32_16x16x32_bf16 v[112:115], a[216:219], v[40:43], v[112:115]
    ds_read_b128 a[196:199], v223 offset:40960
    v_mfma_f32_16x16x32_bf16 v[120:123], a[216:219], v[72:75], v[120:123]
    v_exp_f32 v248, v248
    v_mfma_f32_16x16x32_bf16 v[128:131], a[216:219], v[104:107], v[128:131]
    v_fma_f32 v249, v159, s21, -v218
    s_waitcnt lgkmcnt(2)
    v_mfma_f32_16x16x32_bf16 v[112:115], a[220:223], v[44:47], v[112:115]
    ds_read_b128 a[200:203], v224 offset:40960
    v_mfma_f32_16x16x32_bf16 v[120:123], a[220:223], v[76:79], v[120:123]
    v_exp_f32 v249, v249
    v_mfma_f32_16x16x32_bf16 v[128:131], a[220:223], v[108:111], v[128:131]
    v_cvt_pk_bf16_f32 v172, v184, v185
    v_cvt_pk_bf16_f32 v173, v186, v187
    s_waitcnt lgkmcnt(2)
    v_mfma_f32_16x16x32_bf16 v[116:119], a[192:195], v[16:19], 0
    ds_read_b128 a[204:207], v225 offset:40960
    v_cvt_pk_bf16_f32 v176, v188, v189
    v_mfma_f32_16x16x32_bf16 v[124:127], a[192:195], v[48:51], 0
    v_cvt_pk_bf16_f32 v177, v190, v191
    v_cvt_pk_bf16_f32 v174, v192, v193
    v_mfma_f32_16x16x32_bf16 v[132:135], a[192:195], v[80:83], 0
    v_cvt_pk_bf16_f32 v175, v194, v195
    v_cvt_pk_bf16_f32 v178, v196, v197
    s_waitcnt lgkmcnt(2)
    v_mfma_f32_16x16x32_bf16 v[116:119], a[196:199], v[20:23], v[116:119]
    ds_read_b128 a[208:211], v222 offset:41216
    v_cvt_pk_bf16_f32 v179, v198, v199
    v_mfma_f32_16x16x32_bf16 v[124:127], a[196:199], v[52:55], v[124:127]
    v_cvt_pk_bf16_f32 v180, v242, v243
    v_cvt_pk_bf16_f32 v181, v244, v245
    v_mfma_f32_16x16x32_bf16 v[132:135], a[196:199], v[84:87], v[132:135]
    v_cvt_pk_bf16_f32 v182, v246, v247
    v_cvt_pk_bf16_f32 v183, v248, v249
    s_waitcnt lgkmcnt(2)
    v_mfma_f32_16x16x32_bf16 v[116:119], a[200:203], v[24:27], v[116:119]
    ds_read_b128 a[212:215], v223 offset:41216
    v_mfma_f32_16x16x32_bf16 v[124:127], a[200:203], v[56:59], v[124:127]
    v_mfma_f32_16x16x32_bf16 v[132:135], a[200:203], v[88:91], v[132:135]
    s_waitcnt lgkmcnt(2)
    v_mfma_f32_16x16x32_bf16 v[116:119], a[204:207], v[28:31], v[116:119]
    ds_read_b128 a[216:219], v224 offset:41216
    v_mfma_f32_16x16x32_bf16 v[124:127], a[204:207], v[60:63], v[124:127]
    v_mfma_f32_16x16x32_bf16 v[132:135], a[204:207], v[92:95], v[132:135]
    v_mfma_f32_16x16x32_bf16 v[200:203], v[212:215], v[172:175], 0
    ds_read_b128 a[220:223], v225 offset:41216
    ds_read_b64_tr_b16 a[224:225], v226 offset:16384
    v_mfma_f32_16x16x32_bf16 v[204:207], v[212:215], v[176:179], 0
    ds_read_b64_tr_b16 a[226:227], v226 offset:24576
    ds_read_b64_tr_b16 a[228:229], v227 offset:16384
    v_mfma_f32_16x16x32_bf16 v[208:211], v[212:215], v[180:183], 0
    ds_read_b64_tr_b16 a[230:231], v227 offset:24576
    ds_read_b64_tr_b16 a[232:233], v228 offset:16384
    s_waitcnt lgkmcnt(8)
    v_mfma_f32_16x16x32_bf16 v[116:119], a[208:211], v[32:35], v[116:119]
    ds_read_b64_tr_b16 a[234:235], v228 offset:24576
    v_mfma_f32_16x16x32_bf16 v[124:127], a[208:211], v[64:67], v[124:127]
    v_mfma_f32_16x16x32_bf16 v[132:135], a[208:211], v[96:99], v[132:135]
    s_waitcnt lgkmcnt(8)
    v_mfma_f32_16x16x32_bf16 v[116:119], a[212:215], v[36:39], v[116:119]
    v_mfma_f32_16x16x32_bf16 v[124:127], a[212:215], v[68:71], v[124:127]
    v_mfma_f32_16x16x32_bf16 v[132:135], a[212:215], v[100:103], v[132:135]
    s_waitcnt lgkmcnt(7)
    v_mfma_f32_16x16x32_bf16 v[116:119], a[216:219], v[40:43], v[116:119]
    v_mfma_f32_16x16x32_bf16 v[124:127], a[216:219], v[72:75], v[124:127]
    v_mfma_f32_16x16x32_bf16 v[132:135], a[216:219], v[104:107], v[132:135]
    s_waitcnt lgkmcnt(6)
    v_mfma_f32_16x16x32_bf16 v[116:119], a[220:223], v[44:47], v[116:119]
    v_mfma_f32_16x16x32_bf16 v[124:127], a[220:223], v[76:79], v[124:127]
    v_mfma_f32_16x16x32_bf16 v[132:135], a[220:223], v[108:111], v[132:135]
    v_max3_f32 v250, v200, v204, v208
    v_cmp_nle_f32 vcc, v250, s22
    s_cbranch_vccz L_ok_1
    s_swappc_b64 s[44:45], s[42:43]
L_ok_1:
    v_add_f32 v219, v219, v200
    v_add_f32 v220, v220, v204
    v_add_f32 v221, v221, v208
    s_waitcnt vmcnt(8)
    s_barrier
    s_waitcnt lgkmcnt(4)
    v_mfma_f32_16x16x32_bf16 a[0:3], a[224:227], v[172:175], a[0:3]
    ds_read_b64_tr_b16 a[236:237], v229 offset:16384
    ds_read_b64_tr_b16 a[238:239], v229 offset:24576
    v_mfma_f32_16x16x32_bf16 a[64:67], a[224:227], v[176:179], a[64:67]
    v_fma_f32 v184, v112, s21, -v216
    s_add_u32 m0, s23, 32768
    v_mfma_f32_16x16x32_bf16 a[128:131], a[224:227], v[180:183], a[128:131]
    v_exp_f32 v184, v184
    s_waitcnt lgkmcnt(4)
    v_mfma_f32_16x16x32_bf16 a[4:7], a[228:231], v[172:175], a[4:7]
    ds_read_b64_tr_b16 a[240:241], v230 offset:16384
    ds_read_b64_tr_b16 a[242:243], v230 offset:24576
    v_mfma_f32_16x16x32_bf16 a[68:71], a[228:231], v[176:179], a[68:71]
    v_fma_f32 v185, v113, s21, -v216
    buffer_load_dwordx4 v234, s[8:11], s24 offen offset:0 lds
    v_mfma_f32_16x16x32_bf16 a[132:135], a[228:231], v[180:183], a[132:135]
    v_exp_f32 v185, v185
    s_waitcnt lgkmcnt(4)
    v_mfma_f32_16x16x32_bf16 a[8:11], a[232:235], v[172:175], a[8:11]
    ds_read_b64_tr_b16 a[244:245], v231 offset:16384
    ds_read_b64_tr_b16 a[246:247], v231 offset:24576
    v_mfma_f32_16x16x32_bf16 a[72:75], a[232:235], v[176:179], a[72:75]
    v_fma_f32 v186, v114, s21, -v216
    buffer_load_dwordx4 v235, s[8:11], s24 offen offset:1024 lds
    v_mfma_f32_16x16x32_bf16 a[136:139], a[232:235], v[180:183], a[136:139]
    v_exp_f32 v186, v186
    s_waitcnt lgkmcnt(4)
    v_mfma_f32_16x16x32_bf16 a[12:15], a[236:239], v[172:175], a[12:15]
    ds_read_b64_tr_b16 a[248:249], v232 offset:16384
    ds_read_b64_tr_b16 a[250:251], v232 offset:24576
    v_mfma_f32_16x16x32_bf16 a[76:79], a[236:239], v[176:179], a[76:79]
    v_fma_f32 v187, v115, s21, -v216
    buffer_load_dwordx4 v236, s[8:11], s24 offen offset:2048 lds
    v_mfma_f32_16x16x32_bf16 a[140:143], a[236:239], v[180:183], a[140:143]
    v_exp_f32 v187, v187
    s_waitcnt lgkmcnt(4)
    v_mfma_f32_16x16x32_bf16 a[16:19], a[240:243], v[172:175], a[16:19]
    ds_read_b64_tr_b16 a[252:253], v233 offset:16384
    ds_read_b64_tr_b16 a[254:255], v233 offset:24576
    v_mfma_f32_16x16x32_bf16 a[80:83], a[240:243], v[176:179], a[80:83]
    v_fma_f32 v188, v120, s21, -v217
    buffer_load_dwordx4 v237, s[8:11], s24 offen offset:3072 lds
    v_mfma_f32_16x16x32_bf16 a[144:147], a[240:243], v[180:183], a[144:147]
    v_exp_f32 v188, v188
    s_waitcnt lgkmcnt(4)
    v_mfma_f32_16x16x32_bf16 a[20:23], a[244:247], v[172:175], a[20:23]
    ds_read_b64_tr_b16 a[224:225], v226 offset:16640
    ds_read_b64_tr_b16 a[226:227], v226 offset:24832
    v_mfma_f32_16x16x32_bf16 a[84:87], a[244:247], v[176:179], a[84:87]
    v_fma_f32 v189, v121, s21, -v217
    s_add_u32 s24, s24, 16384
    v_mfma_f32_16x16x32_bf16 a[148:151], a[244:247], v[180:183], a[148:151]
    v_exp_f32 v189, v189
    s_waitcnt lgkmcnt(4)
    v_mfma_f32_16x16x32_bf16 a[24:27], a[248:251], v[172:175], a[24:27]
    ds_read_b64_tr_b16 a[228:229], v227 offset:16640
    ds_read_b64_tr_b16 a[230:231], v227 offset:24832
    v_mfma_f32_16x16x32_bf16 a[88:91], a[248:251], v[176:179], a[88:91]
    v_fma_f32 v190, v122, s21, -v217
    s_add_u32 m0, s23, 65536
    v_mfma_f32_16x16x32_bf16 a[152:155], a[248:251], v[180:183], a[152:155]
    v_exp_f32 v190, v190
    s_waitcnt lgkmcnt(4)
    v_mfma_f32_16x16x32_bf16 a[28:31], a[252:255], v[172:175], a[28:31]
    ds_read_b64_tr_b16 a[232:233], v228 offset:16640
    ds_read_b64_tr_b16 a[234:235], v228 offset:24832
    v_mfma_f32_16x16x32_bf16 a[92:95], a[252:255], v[176:179], a[92:95]
    v_fma_f32 v191, v123, s21, -v217
    buffer_load_dwordx4 v238, s[12:15], s25 offen offset:0 lds
    v_mfma_f32_16x16x32_bf16 a[156:159], a[252:255], v[180:183], a[156:159]
    v_exp_f32 v191, v191
    s_waitcnt lgkmcnt(4)
    v_mfma_f32_16x16x32_bf16 a[32:35], a[224:227], v[172:175], a[32:35]
    ds_read_b64_tr_b16 a[236:237], v229 offset:16640
    ds_read_b64_tr_b16 a[238:239], v229 offset:24832
    v_mfma_f32_16x16x32_bf16 a[96:99], a[224:227], v[176:179], a[96:99]
    v_fma_f32 v192, v116, s21, -v216
    buffer_load_dwordx4 v239, s[12:15], s25 offen offset:1024 lds
    v_mfma_f32_16x16x32_bf16 a[160:163], a[224:227], v[180:183], a[160:163]
    v_exp_f32 v192, v192
    s_waitcnt lgkmcnt(4)
    v_mfma_f32_16x16x32_bf16 a[36:39], a[228:231], v[172:175], a[36:39]
    ds_read_b64_tr_b16 a[240:241], v230 offset:16640
    ds_read_b64_tr_b16 a[242:243], v230 offset:24832
    v_mfma_f32_16x16x32_bf16 a[100:103], a[228:231], v[176:179], a[100:103]
    v_fma_f32 v193, v117, s21, -v216
    buffer_load_dwordx4 v240, s[12:15], s25 offen offset:2048 lds
    v_mfma_f32_16x16x32_bf16 a[164:167], a[228:231], v[180:183], a[164:167]
    v_exp_f32 v193, v193
    s_waitcnt lgkmcnt(4)
    v_mfma_f32_16x16x32_bf16 a[40:43], a[232:235], v[172:175], a[40:43]
    ds_read_b64_tr_b16 a[244:245], v231 offset:16640
    ds_read_b64_tr_b16 a[246:247], v231 offset:24832
    v_mfma_f32_16x16x32_bf16 a[104:107], a[232:235], v[176:179], a[104:107]
    v_fma_f32 v194, v118, s21, -v216
    buffer_load_dwordx4 v241, s[12:15], s25 offen offset:3072 lds
    v_mfma_f32_16x16x32_bf16 a[168:171], a[232:235], v[180:183], a[168:171]
    v_exp_f32 v194, v194
    s_waitcnt lgkmcnt(4)
    v_mfma_f32_16x16x32_bf16 a[44:47], a[236:239], v[172:175], a[44:47]
    ds_read_b64_tr_b16 a[248:249], v232 offset:16640
    ds_read_b64_tr_b16 a[250:251], v232 offset:24832
    v_mfma_f32_16x16x32_bf16 a[108:111], a[236:239], v[176:179], a[108:111]
    v_fma_f32 v195, v119, s21, -v216
    s_add_u32 s25, s25, 16384
    v_mfma_f32_16x16x32_bf16 a[172:175], a[236:239], v[180:183], a[172:175]
    v_exp_f32 v195, v195
    s_waitcnt lgkmcnt(4)
    v_mfma_f32_16x16x32_bf16 a[48:51], a[240:243], v[172:175], a[48:51]
    ds_read_b64_tr_b16 a[252:253], v233 offset:16640
    ds_read_b64_tr_b16 a[254:255], v233 offset:24832
    v_mfma_f32_16x16x32_bf16 a[112:115], a[240:243], v[176:179], a[112:115]
    v_fma_f32 v196, v124, s21, -v217
    ds_read_b128 a[192:195], v222 offset:49152
    v_mfma_f32_16x16x32_bf16 a[176:179], a[240:243], v[180:183], a[176:179]
    v_exp_f32 v196, v196
    s_waitcnt lgkmcnt(5)
    v_mfma_f32_16x16x32_bf16 a[52:55], a[244:247], v[172:175], a[52:55]
    v_fma_f32 v197, v125, s21, -v217
    ds_read_b128 a[196:199], v223 offset:49152
    v_mfma_f32_16x16x32_bf16 a[116:119], a[244:247], v[176:179], a[116:119]
    v_exp_f32 v197, v197
    v_mfma_f32_16x16x32_bf16 a[180:183], a[244:247], v[180:183], a[180:183]
    v_fma_f32 v198, v126, s21, -v217
    ds_read_b128 a[200:203], v224 offset:49152
    s_waitcnt lgkmcnt(5)
    v_mfma_f32_16x16x32_bf16 a[56:59], a[248:251], v[172:175], a[56:59]
    v_exp_f32 v198, v198
    v_mfma_f32_16x16x32_bf16 a[120:123], a[248:251], v[176:179], a[120:123]
    v_fma_f32 v199, v127, s21, -v217
    v_mfma_f32_16x16x32_bf16 a[184:187], a[248:251], v[180:183], a[184:187]
    v_exp_f32 v199, v199
    s_waitcnt lgkmcnt(3)
    v_mfma_f32_16x16x32_bf16 a[60:63], a[252:255], v[172:175], a[60:63]
    v_mfma_f32_16x16x32_bf16 a[124:127], a[252:255], v[176:179], a[124:127]
    v_mfma_f32_16x16x32_bf16 a[188:191], a[252:255], v[180:183], a[188:191]
    s_waitcnt lgkmcnt(2)
    v_mfma_f32_16x16x32_bf16 v[136:139], a[192:195], v[16:19], 0
    ds_read_b128 a[204:207], v225 offset:49152
    v_fma_f32 v242, v128, s21, -v218
    v_mfma_f32_16x16x32_bf16 v[144:147], a[192:195], v[48:51], 0
    v_exp_f32 v242, v242
    v_mfma_f32_16x16x32_bf16 v[152:155], a[192:195], v[80:83], 0
    v_fma_f32 v243, v129, s21, -v218
    s_waitcnt lgkmcnt(2)
    v_mfma_f32_16x16x32_bf16 v[136:139], a[196:199], v[20:23], v[136:139]
    ds_read_b128 a[208:211], v222 offset:49408
    v_mfma_f32_16x16x32_bf16 v[144:147], a[196:199], v[52:55], v[144:147]
    v_exp_f32 v243, v243
    v_mfma_f32_16x16x32_bf16 v[152:155], a[196:199], v[84:87], v[152:155]
    v_fma_f32 v244, v130, s21, -v218
    s_waitcnt lgkmcnt(2)
    v_mfma_f32_16x16x32_bf16 v[136:139], a[200:203], v[24:27], v[136:139]
    ds_read_b128 a[212:215], v223 offset:49408
    v_mfma_f32_16x16x32_bf16 v[144:147], a[200:203], v[56:59], v[144:147]
    v_exp_f32 v244, v244
    v_mfma_f32_16x16x32_bf16 v[152:155], a[200:203], v[88:91], v[152:155]
    v_fma_f32 v245, v131, s21, -v218
    s_waitcnt lgkmcnt(2)
    v_mfma_f32_16x16x32_bf16 v[136:139], a[204:207], v[28:31], v[136:139]
    ds_read_b128 a[216:219], v224 offset:49408
    v_mfma_f32_16x16x32_bf16 v[144:147], a[204:207], v[60:63], v[144:147]
    v_exp_f32 v245, v245
    v_mfma_f32_16x16x32_bf16 v[152:155], a[204:207], v[92:95], v[152:155]
    v_fma_f32 v246, v132, s21, -v218
    s_waitcnt lgkmcnt(2)
    v_mfma_f32_16x16x32_bf16 v[136:139], a[208:211], v[32:35], v[136:139]
    ds_read_b128 a[220:223], v225 offset:49408
    v_mfma_f32_16x16x32_bf16 v[144:147], a[208:211], v[64:67], v[144:147]
    v_exp_f32 v246, v246
    v_mfma_f32_16x16x32_bf16 v[152:155], a[208:211], v[96:99], v[152:155]
    v_fma_f32 v247, v133, s21, -v218
    s_waitcnt lgkmcnt(2)
    v_mfma_f32_16x16x32_bf16 v[136:139], a[212:215], v[36:39], v[136:139]
    ds_read_b128 a[192:195], v222 offset:57344
    v_mfma_f32_16x16x32_bf16 v[144:147], a[212:215], v[68:71], v[144:147]
    v_exp_f32 v247, v247
    v_mfma_f32_16x16x32_bf16 v[152:155], a[212:215], v[100:103], v[152:155]
    v_fma_f32 v248, v134, s21, -v218
    s_waitcnt lgkmcnt(2)
    v_mfma_f32_16x16x32_bf16 v[136:139], a[216:219], v[40:43], v[136:139]
    ds_read_b128 a[196:199], v223 offset:57344
    v_mfma_f32_16x16x32_bf16 v[144:147], a[216:219], v[72:75], v[144:147]
    v_exp_f32 v248, v248
    v_mfma_f32_16x16x32_bf16 v[152:155], a[216:219], v[104:107], v[152:155]
    v_fma_f32 v249, v135, s21, -v218
    s_waitcnt lgkmcnt(2)
    v_mfma_f32_16x16x32_bf16 v[136:139], a[220:223], v[44:47], v[136:139]
    ds_read_b128 a[200:203], v224 offset:57344
    v_mfma_f32_16x16x32_bf16 v[144:147], a[220:223], v[76:79], v[144:147]
    v_exp_f32 v249, v249
    v_mfma_f32_16x16x32_bf16 v[152:155], a[220:223], v[108:111], v[152:155]
    v_cvt_pk_bf16_f32 v160, v184, v185
    v_cvt_pk_bf16_f32 v161, v186, v187
    s_waitcnt lgkmcnt(2)
    v_mfma_f32_16x16x32_bf16 v[140:143], a[192:195], v[16:19], 0
    ds_read_b128 a[204:207], v225 offset:57344
    v_cvt_pk_bf16_f32 v164, v188, v189
    v_mfma_f32_16x16x32_bf16 v[148:151], a[192:195], v[48:51], 0
    v_cvt_pk_bf16_f32 v165, v190, v191
    v_cvt_pk_bf16_f32 v162, v192, v193
    v_mfma_f32_16x16x32_bf16 v[156:159], a[192:195], v[80:83], 0
    v_cvt_pk_bf16_f32 v163, v194, v195
    v_cvt_pk_bf16_f32 v166, v196, v197
    s_waitcnt lgkmcnt(2)
    v_mfma_f32_16x16x32_bf16 v[140:143], a[196:199], v[20:23], v[140:143]
    ds_read_b128 a[208:211], v222 offset:57600
    v_cvt_pk_bf16_f32 v167, v198, v199
    v_mfma_f32_16x16x32_bf16 v[148:151], a[196:199], v[52:55], v[148:151]
    v_cvt_pk_bf16_f32 v168, v242, v243
    v_cvt_pk_bf16_f32 v169, v244, v245
    v_mfma_f32_16x16x32_bf16 v[156:159], a[196:199], v[84:87], v[156:159]
    v_cvt_pk_bf16_f32 v170, v246, v247
    v_cvt_pk_bf16_f32 v171, v248, v249
    s_waitcnt lgkmcnt(2)
    v_mfma_f32_16x16x32_bf16 v[140:143], a[200:203], v[24:27], v[140:143]
    ds_read_b128 a[212:215], v223 offset:57600
    v_mfma_f32_16x16x32_bf16 v[148:151], a[200:203], v[56:59], v[148:151]
    v_mfma_f32_16x16x32_bf16 v[156:159], a[200:203], v[88:91], v[156:159]
    s_waitcnt lgkmcnt(2)
    v_mfma_f32_16x16x32_bf16 v[140:143], a[204:207], v[28:31], v[140:143]
    ds_read_b128 a[216:219], v224 offset:57600
    v_mfma_f32_16x16x32_bf16 v[148:151], a[204:207], v[60:63], v[148:151]
    v_mfma_f32_16x16x32_bf16 v[156:159], a[204:207], v[92:95], v[156:159]
    v_mfma_f32_16x16x32_bf16 v[200:203], v[212:215], v[160:163], 0
    ds_read_b128 a[220:223], v225 offset:57600
    ds_read_b64_tr_b16 a[224:225], v226 offset:32768
    v_mfma_f32_16x16x32_bf16 v[204:207], v[212:215], v[164:167], 0
    ds_read_b64_tr_b16 a[226:227], v226 offset:40960
    ds_read_b64_tr_b16 a[228:229], v227 offset:32768
    v_mfma_f32_16x16x32_bf16 v[208:211], v[212:215], v[168:171], 0
    ds_read_b64_tr_b16 a[230:231], v227 offset:40960
    ds_read_b64_tr_b16 a[232:233], v228 offset:32768
    s_waitcnt lgkmcnt(8)
    v_mfma_f32_16x16x32_bf16 v[140:143], a[208:211], v[32:35], v[140:143]
    ds_read_b64_tr_b16 a[234:235], v228 offset:40960
    v_mfma_f32_16x16x32_bf16 v[148:151], a[208:211], v[64:67], v[148:151]
    v_mfma_f32_16x16x32_bf16 v[156:159], a[208:211], v[96:99], v[156:159]
    s_waitcnt lgkmcnt(8)
    v_mfma_f32_16x16x32_bf16 v[140:143], a[212:215], v[36:39], v[140:143]
    v_mfma_f32_16x16x32_bf16 v[148:151], a[212:215], v[68:71], v[148:151]
    v_mfma_f32_16x16x32_bf16 v[156:159], a[212:215], v[100:103], v[156:159]
    s_waitcnt lgkmcnt(7)
    v_mfma_f32_16x16x32_bf16 v[140:143], a[216:219], v[40:43], v[140:143]
    v_mfma_f32_16x16x32_bf16 v[148:151], a[216:219], v[72:75], v[148:151]
    v_mfma_f32_16x16x32_bf16 v[156:159], a[216:219], v[104:107], v[156:159]
    s_waitcnt lgkmcnt(6)
    v_mfma_f32_16x16x32_bf16 v[140:143], a[220:223], v[44:47], v[140:143]
    v_mfma_f32_16x16x32_bf16 v[148:151], a[220:223], v[76:79], v[148:151]
    v_mfma_f32_16x16x32_bf16 v[156:159], a[220:223], v[108:111], v[156:159]
    v_max3_f32 v250, v200, v204, v208
    v_cmp_nle_f32 vcc, v250, s22
    s_cbranch_vccz L_ok_2
    s_swappc_b64 s[44:45], s[40:41]
L_ok_2:
    v_add_f32 v219, v219, v200
    v_add_f32 v220, v220, v204
    v_add_f32 v221, v221, v208
    s_waitcnt vmcnt(8)
    s_barrier
    s_waitcnt lgkmcnt(4)
    v_mfma_f32_16x16x32_bf16 a[0:3], a[224:227], v[160:163], a[0:3]
    ds_read_b64_tr_b16 a[236:237], v229 offset:32768
    ds_read_b64_tr_b16 a[238:239], v229 offset:40960
    v_mfma_f32_16x16x32_bf16 a[64:67], a[224:227], v[164:167], a[64:67]
    v_fma_f32 v184, v136, s21, -v216
    s_add_u32 m0, s23, 49152
    v_mfma_f32_16x16x32_bf16 a[128:131], a[224:227], v[168:171], a[128:131]
    v_exp_f32 v184, v184
    s_waitcnt lgkmcnt(4)
    v_mfma_f32_16x16x32_bf16 a[4:7], a[228:231], v[160:163], a[4:7]
    ds_read_b64_tr_b16 a[240:241], v230 offset:32768
    ds_read_b64_tr_b16 a[242:243], v230 offset:40960
    v_mfma_f32_16x16x32_bf16 a[68:71], a[228:231], v[164:167], a[68:71]
    v_fma_f32 v185, v137, s21, -v216
    buffer_load_dwordx4 v234, s[8:11], s24 offen offset:0 lds
    v_mfma_f32_16x16x32_bf16 a[132:135], a[228:231], v[168:171], a[132:135]
    v_exp_f32 v185, v185
    s_waitcnt lgkmcnt(4)
    v_mfma_f32_16x16x32_bf16 a[8:11], a[232:235], v[160:163], a[8:11]
    ds_read_b64_tr_b16 a[244:245], v231 offset:32768
    ds_read_b64_tr_b16 a[246:247], v231 offset:40960
    v_mfma_f32_16x16x32_bf16 a[72:75], a[232:235], v[164:167], a[72:75]
    v_fma_f32 v186, v138, s21, -v216
    buffer_load_dwordx4 v235, s[8:11], s24 offen offset:1024 lds
    v_mfma_f32_16x16x32_bf16 a[136:139], a[232:235], v[168:171], a[136:139]
    v_exp_f32 v186, v186
    s_waitcnt lgkmcnt(4)
    v_mfma_f32_16x16x32_bf16 a[12:15], a[236:239], v[160:163], a[12:15]
    ds_read_b64_tr_b16 a[248:249], v232 offset:32768
    ds_read_b64_tr_b16 a[250:251], v232 offset:40960
    v_mfma_f32_16x16x32_bf16 a[76:79], a[236:239], v[164:167], a[76:79]
    v_fma_f32 v187, v139, s21, -v216
    buffer_load_dwordx4 v236, s[8:11], s24 offen offset:2048 lds
    v_mfma_f32_16x16x32_bf16 a[140:143], a[236:239], v[168:171], a[140:143]
    v_exp_f32 v187, v187
    s_waitcnt lgkmcnt(4)
    v_mfma_f32_16x16x32_bf16 a[16:19], a[240:243], v[160:163], a[16:19]
    ds_read_b64_tr_b16 a[252:253], v233 offset:32768
    ds_read_b64_tr_b16 a[254:255], v233 offset:40960
    v_mfma_f32_16x16x32_bf16 a[80:83], a[240:243], v[164:167], a[80:83]
    v_fma_f32 v188, v144, s21, -v217
    buffer_load_dwordx4 v237, s[8:11], s24 offen offset:3072 lds
    v_mfma_f32_16x16x32_bf16 a[144:147], a[240:243], v[168:171], a[144:147]
    v_exp_f32 v188, v188
    s_waitcnt lgkmcnt(4)
    v_mfma_f32_16x16x32_bf16 a[20:23], a[244:247], v[160:163], a[20:23]
    ds_read_b64_tr_b16 a[224:225], v226 offset:33024
    ds_read_b64_tr_b16 a[226:227], v226 offset:41216
    v_mfma_f32_16x16x32_bf16 a[84:87], a[244:247], v[164:167], a[84:87]
    v_fma_f32 v189, v145, s21, -v217
    s_add_u32 s24, s24, 16384
    v_mfma_f32_16x16x32_bf16 a[148:151], a[244:247], v[168:171], a[148:151]
    v_exp_f32 v189, v189
    s_waitcnt lgkmcnt(4)
    v_mfma_f32_16x16x32_bf16 a[24:27], a[248:251], v[160:163], a[24:27]
    ds_read_b64_tr_b16 a[228:229], v227 offset:33024
    ds_read_b64_tr_b16 a[230:231], v227 offset:41216
    v_mfma_f32_16x16x32_bf16 a[88:91], a[248:251], v[164:167], a[88:91]
    v_fma_f32 v190, v146, s21, -v217
    s_add_u32 m0, s23, 81920
    v_mfma_f32_16x16x32_bf16 a[152:155], a[248:251], v[168:171], a[152:155]
    v_exp_f32 v190, v190
    s_waitcnt lgkmcnt(4)
    v_mfma_f32_16x16x32_bf16 a[28:31], a[252:255], v[160:163], a[28:31]
    ds_read_b64_tr_b16 a[232:233], v228 offset:33024
    ds_read_b64_tr_b16 a[234:235], v228 offset:41216
    v_mfma_f32_16x16x32_bf16 a[92:95], a[252:255], v[164:167], a[92:95]
    v_fma_f32 v191, v147, s21, -v217
    buffer_load_dwordx4 v238, s[12:15], s25 offen offset:0 lds
    v_mfma_f32_16x16x32_bf16 a[156:159], a[252:255], v[168:171], a[156:159]
    v_exp_f32 v191, v191
    s_waitcnt lgkmcnt(4)
    v_mfma_f32_16x16x32_bf16 a[32:35], a[224:227], v[160:163], a[32:35]
    ds_read_b64_tr_b16 a[236:237], v229 offset:33024
    ds_read_b64_tr_b16 a[238:239], v229 offset:41216
    v_mfma_f32_16x16x32_bf16 a[96:99], a[224:227], v[164:167], a[96:99]
    v_fma_f32 v192, v140, s21, -v216
    buffer_load_dwordx4 v239, s[12:15], s25 offen offset:1024 lds
    v_mfma_f32_16x16x32_bf16 a[160:163], a[224:227], v[168:171], a[160:163]
    v_exp_f32 v192, v192
    s_waitcnt lgkmcnt(4)
    v_mfma_f32_16x16x32_bf16 a[36:39], a[228:231], v[160:163], a[36:39]
    ds_read_b64_tr_b16 a[240:241], v230 offset:33024
    ds_read_b64_tr_b16 a[242:243], v230 offset:41216
    v_mfma_f32_16x16x32_bf16 a[100:103], a[228:231], v[164:167], a[100:103]
    v_fma_f32 v193, v141, s21, -v216
    buffer_load_dwordx4 v240, s[12:15], s25 offen offset:2048 lds
    v_mfma_f32_16x16x32_bf16 a[164:167], a[228:231], v[168:171], a[164:167]
    v_exp_f32 v193, v193
    s_waitcnt lgkmcnt(4)
    v_mfma_f32_16x16x32_bf16 a[40:43], a[232:235], v[160:163], a[40:43]
    ds_read_b64_tr_b16 a[244:245], v231 offset:33024
    ds_read_b64_tr_b16 a[246:247], v231 offset:41216
    v_mfma_f32_16x16x32_bf16 a[104:107], a[232:235], v[164:167], a[104:107]
    v_fma_f32 v194, v142, s21, -v216
    buffer_load_dwordx4 v241, s[12:15], s25 offen offset:3072 lds
    v_mfma_f32_16x16x32_bf16 a[168:171], a[232:235], v[168:171], a[168:171]
    v_exp_f32 v194, v194
    s_waitcnt lgkmcnt(4)
    v_mfma_f32_16x16x32_bf16 a[44:47], a[236:239], v[160:163], a[44:47]
    ds_read_b64_tr_b16 a[248:249], v232 offset:33024
    ds_read_b64_tr_b16 a[250:251], v232 offset:41216
    v_mfma_f32_16x16x32_bf16 a[108:111], a[236:239], v[164:167], a[108:111]
    v_fma_f32 v195, v143, s21, -v216
    s_add_u32 s25, s25, 16384
    v_mfma_f32_16x16x32_bf16 a[172:175], a[236:239], v[168:171], a[172:175]
    v_exp_f32 v195, v195
    s_waitcnt lgkmcnt(4)
    v_mfma_f32_16x16x32_bf16 a[48:51], a[240:243], v[160:163], a[48:51]
    ds_read_b64_tr_b16 a[252:253], v233 offset:33024
    ds_read_b64_tr_b16 a[254:255], v233 offset:41216
    v_mfma_f32_16x16x32_bf16 a[112:115], a[240:243], v[164:167], a[112:115]
    v_fma_f32 v196, v148, s21, -v217
    ds_read_b128 a[192:195], v222 offset:0
    v_mfma_f32_16x16x32_bf16 a[176:179], a[240:243], v[168:171], a[176:179]
    v_exp_f32 v196, v196
    s_waitcnt lgkmcnt(5)
    v_mfma_f32_16x16x32_bf16 a[52:55], a[244:247], v[160:163], a[52:55]
    v_fma_f32 v197, v149, s21, -v217
    ds_read_b128 a[196:199], v223 offset:0
    v_mfma_f32_16x16x32_bf16 a[116:119], a[244:247], v[164:167], a[116:119]
    v_exp_f32 v197, v197
    v_mfma_f32_16x16x32_bf16 a[180:183], a[244:247], v[168:171], a[180:183]
    v_fma_f32 v198, v150, s21, -v217
    ds_read_b128 a[200:203], v224 offset:0
    s_waitcnt lgkmcnt(5)
    v_mfma_f32_16x16x32_bf16 a[56:59], a[248:251], v[160:163], a[56:59]
    v_exp_f32 v198, v198
    v_mfma_f32_16x16x32_bf16 a[120:123], a[248:251], v[164:167], a[120:123]
    v_fma_f32 v199, v151, s21, -v217
    v_mfma_f32_16x16x32_bf16 a[184:187], a[248:251], v[168:171], a[184:187]
    v_exp_f32 v199, v199
    s_waitcnt lgkmcnt(3)
    v_mfma_f32_16x16x32_bf16 a[60:63], a[252:255], v[160:163], a[60:63]
    v_mfma_f32_16x16x32_bf16 a[124:127], a[252:255], v[164:167], a[124:127]
    v_mfma_f32_16x16x32_bf16 a[188:191], a[252:255], v[168:171], a[188:191]
    s_waitcnt lgkmcnt(2)
    v_mfma_f32_16x16x32_bf16 v[112:115], a[192:195], v[16:19], 0
    ds_read_b128 a[204:207], v225 offset:0
    v_fma_f32 v242, v152, s21, -v218
    v_mfma_f32_16x16x32_bf16 v[120:123], a[192:195], v[48:51], 0
    v_exp_f32 v242, v242
    v_mfma_f32_16x16x32_bf16 v[128:131], a[192:195], v[80:83], 0
    v_fma_f32 v243, v153, s21, -v218
    s_waitcnt lgkmcnt(2)
    v_mfma_f32_16x16x32_bf16 v[112:115], a[196:199], v[20:23], v[112:115]
    ds_read_b128 a[208:211], v222 offset:256
    v_mfma_f32_16x16x32_bf16 v[120:123], a[196:199], v[52:55], v[120:123]
    v_exp_f32 v243, v243
    v_mfma_f32_16x16x32_bf16 v[128:131], a[196:199], v[84:87], v[128:131]
    v_fma_f32 v244, v154, s21, -v218
    s_waitcnt lgkmcnt(2)
    v_mfma_f32_16x16x32_bf16 v[112:115], a[200:203], v[24:27], v[112:115]
    ds_read_b128 a[212:215], v223 offset:256
    v_mfma_f32_16x16x32_bf16 v[120:123], a[200:203], v[56:59], v[120:123]
    v_exp_f32 v244, v244
    v_mfma_f32_16x16x32_bf16 v[128:131], a[200:203], v[88:91], v[128:131]
    v_fma_f32 v245, v155, s21, -v218
    s_waitcnt lgkmcnt(2)
    v_mfma_f32_16x16x32_bf16 v[112:115], a[204:207], v[28:31], v[112:115]
    ds_read_b128 a[216:219], v224 offset:256
    v_mfma_f32_16x16x32_bf16 v[120:123], a[204:207], v[60:63], v[120:123]
    v_exp_f32 v245, v245
    v_mfma_f32_16x16x32_bf16 v[128:131], a[204:207], v[92:95], v[128:131]
    v_fma_f32 v246, v156, s21, -v218
    s_waitcnt lgkmcnt(2)
    v_mfma_f32_16x16x32_bf16 v[112:115], a[208:211], v[32:35], v[112:115]
    ds_read_b128 a[220:223], v225 offset:256
    v_mfma_f32_16x16x32_bf16 v[120:123], a[208:211], v[64:67], v[120:123]
    v_exp_f32 v246, v246
    v_mfma_f32_16x16x32_bf16 v[128:131], a[208:211], v[96:99], v[128:131]
    v_fma_f32 v247, v157, s21, -v218
    s_waitcnt lgkmcnt(2)
    v_mfma_f32_16x16x32_bf16 v[112:115], a[212:215], v[36:39], v[112:115]
    ds_read_b128 a[192:195], v222 offset:8192
    v_mfma_f32_16x16x32_bf16 v[120:123], a[212:215], v[68:71], v[120:123]
    v_exp_f32 v247, v247
    v_mfma_f32_16x16x32_bf16 v[128:131], a[212:215], v[100:103], v[128:131]
    v_fma_f32 v248, v158, s21, -v218
    s_waitcnt lgkmcnt(2)
    v_mfma_f32_16x16x32_bf16 v[112:115], a[216:219], v[40:43], v[112:115]
    ds_read_b128 a[196:199], v223 offset:8192
    v_mfma_f32_16x16x32_bf16 v[120:123], a[216:219], v[72:75], v[120:123]
    v_exp_f32 v248, v248
    v_mfma_f32_16x16x32_bf16 v[128:131], a[216:219], v[104:107], v[128:131]
    v_fma_f32 v249, v159, s21, -v218
    s_waitcnt lgkmcnt(2)
    v_mfma_f32_16x16x32_bf16 v[112:115], a[220:223], v[44:47], v[112:115]
    ds_read_b128 a[200:203], v224 offset:8192
    v_mfma_f32_16x16x32_bf16 v[120:123], a[220:223], v[76:79], v[120:123]
    v_exp_f32 v249, v249
    v_mfma_f32_16x16x32_bf16 v[128:131], a[220:223], v[108:111], v[128:131]
    v_cvt_pk_bf16_f32 v172, v184, v185
    v_cvt_pk_bf16_f32 v173, v186, v187
    s_waitcnt lgkmcnt(2)
    v_mfma_f32_16x16x32_bf16 v[116:119], a[192:195], v[16:19], 0
    ds_read_b128 a[204:207], v225 offset:8192
    v_cvt_pk_bf16_f32 v176, v188, v189
    v_mfma_f32_16x16x32_bf16 v[124:127], a[192:195], v[48:51], 0
    v_cvt_pk_bf16_f32 v177, v190, v191
    v_cvt_pk_bf16_f32 v174, v192, v193
    v_mfma_f32_16x16x32_bf16 v[132:135], a[192:195], v[80:83], 0
    v_cvt_pk_bf16_f32 v175, v194, v195
    v_cvt_pk_bf16_f32 v178, v196, v197
    s_waitcnt lgkmcnt(2)
    v_mfma_f32_16x16x32_bf16 v[116:119], a[196:199], v[20:23], v[116:119]
    ds_read_b128 a[208:211], v222 offset:8448
    v_cvt_pk_bf16_f32 v179, v198, v199
    v_mfma_f32_16x16x32_bf16 v[124:127], a[196:199], v[52:55], v[124:127]
    v_cvt_pk_bf16_f32 v180, v242, v243
    v_cvt_pk_bf16_f32 v181, v244, v245
    v_mfma_f32_16x16x32_bf16 v[132:135], a[196:199], v[84:87], v[132:135]
    v_cvt_pk_bf16_f32 v182, v246, v247
    v_cvt_pk_bf16_f32 v183, v248, v249
    s_waitcnt lgkmcnt(2)
    v_mfma_f32_16x16x32_bf16 v[116:119], a[200:203], v[24:27], v[116:119]
    ds_read_b128 a[212:215], v223 offset:8448
    v_mfma_f32_16x16x32_bf16 v[124:127], a[200:203], v[56:59], v[124:127]
    v_mfma_f32_16x16x32_bf16 v[132:135], a[200:203], v[88:91], v[132:135]
    s_waitcnt lgkmcnt(2)
    v_mfma_f32_16x16x32_bf16 v[116:119], a[204:207], v[28:31], v[116:119]
    ds_read_b128 a[216:219], v224 offset:8448
    v_mfma_f32_16x16x32_bf16 v[124:127], a[204:207], v[60:63], v[124:127]
    v_mfma_f32_16x16x32_bf16 v[132:135], a[204:207], v[92:95], v[132:135]
    v_mfma_f32_16x16x32_bf16 v[200:203], v[212:215], v[172:175], 0
    ds_read_b128 a[220:223], v225 offset:8448
    ds_read_b64_tr_b16 a[224:225], v226 offset:49152
    v_mfma_f32_16x16x32_bf16 v[204:207], v[212:215], v[176:179], 0
    ds_read_b64_tr_b16 a[226:227], v226 offset:57344
    ds_read_b64_tr_b16 a[228:229], v227 offset:49152
    v_mfma_f32_16x16x32_bf16 v[208:211], v[212:215], v[180:183], 0
    ds_read_b64_tr_b16 a[230:231], v227 offset:57344
    ds_read_b64_tr_b16 a[232:233], v228 offset:49152
    s_waitcnt lgkmcnt(8)
    v_mfma_f32_16x16x32_bf16 v[116:119], a[208:211], v[32:35], v[116:119]
    ds_read_b64_tr_b16 a[234:235], v228 offset:57344
    v_mfma_f32_16x16x32_bf16 v[124:127], a[208:211], v[64:67], v[124:127]
    v_mfma_f32_16x16x32_bf16 v[132:135], a[208:211], v[96:99], v[132:135]
    s_waitcnt lgkmcnt(8)
    v_mfma_f32_16x16x32_bf16 v[116:119], a[212:215], v[36:39], v[116:119]
    v_mfma_f32_16x16x32_bf16 v[124:127], a[212:215], v[68:71], v[124:127]
    v_mfma_f32_16x16x32_bf16 v[132:135], a[212:215], v[100:103], v[132:135]
    s_waitcnt lgkmcnt(7)
    v_mfma_f32_16x16x32_bf16 v[116:119], a[216:219], v[40:43], v[116:119]
    v_mfma_f32_16x16x32_bf16 v[124:127], a[216:219], v[72:75], v[124:127]
    v_mfma_f32_16x16x32_bf16 v[132:135], a[216:219], v[104:107], v[132:135]
    s_waitcnt lgkmcnt(6)
    v_mfma_f32_16x16x32_bf16 v[116:119], a[220:223], v[44:47], v[116:119]
    v_mfma_f32_16x16x32_bf16 v[124:127], a[220:223], v[76:79], v[124:127]
    v_mfma_f32_16x16x32_bf16 v[132:135], a[220:223], v[108:111], v[132:135]
    v_max3_f32 v250, v200, v204, v208
    v_cmp_nle_f32 vcc, v250, s22
    s_cbranch_vccz L_ok_3
    s_swappc_b64 s[44:45], s[42:43]
L_ok_3:
    v_add_f32 v219, v219, v200
    v_add_f32 v220, v220, v204
    v_add_f32 v221, v221, v208
    s_waitcnt vmcnt(8)
    s_barrier
    s_waitcnt lgkmcnt(4)
    v_mfma_f32_16x16x32_bf16 a[0:3], a[224:227], v[172:175], a[0:3]
    ds_read_b64_tr_b16 a[236:237], v229 offset:49152
    ds_read_b64_tr_b16 a[238:239], v229 offset:57344
    v_mfma_f32_16x16x32_bf16 a[64:67], a[224:227], v[176:179], a[64:67]
    v_fma_f32 v184, v112, s21, -v216
    s_add_u32 m0, s23, 0
    v_mfma_f32_16x16x32_bf16 a[128:131], a[224:227], v[180:183], a[128:131]
    v_exp_f32 v184, v184
    s_waitcnt lgkmcnt(4)
    v_mfma_f32_16x16x32_bf16 a[4:7], a[228:231], v[172:175], a[4:7]
    ds_read_b64_tr_b16 a[240:241], v230 offset:49152
    ds_read_b64_tr_b16 a[242:243], v230 offset:57344
    v_mfma_f32_16x16x32_bf16 a[68:71], a[228:231], v[176:179], a[68:71]
    v_fma_f32 v185, v113, s21, -v216
    buffer_load_dwordx4 v234, s[8:11], s24 offen offset:0 lds
    v_mfma_f32_16x16x32_bf16 a[132:135], a[228:231], v[180:183], a[132:135]
    v_exp_f32 v185, v185
    s_waitcnt lgkmcnt(4)
    v_mfma_f32_16x16x32_bf16 a[8:11], a[232:235], v[172:175], a[8:11]
    ds_read_b64_tr_b16 a[244:245], v231 offset:49152
    ds_read_b64_tr_b16 a[246:247], v231 offset:57344
    v_mfma_f32_16x16x32_bf16 a[72:75], a[232:235], v[176:179], a[72:75]
    v_fma_f32 v186, v114, s21, -v216
    buffer_load_dwordx4 v235, s[8:11], s24 offen offset:1024 lds
    v_mfma_f32_16x16x32_bf16 a[136:139], a[232:235], v[180:183], a[136:139]
    v_exp_f32 v186, v186
    s_waitcnt lgkmcnt(4)
    v_mfma_f32_16x16x32_bf16 a[12:15], a[236:239], v[172:175], a[12:15]
    ds_read_b64_tr_b16 a[248:249], v232 offset:49152
    ds_read_b64_tr_b16 a[250:251], v232 offset:57344
    v_mfma_f32_16x16x32_bf16 a[76:79], a[236:239], v[176:179], a[76:79]
    v_fma_f32 v187, v115, s21, -v216
    buffer_load_dwordx4 v236, s[8:11], s24 offen offset:2048 lds
    v_mfma_f32_16x16x32_bf16 a[140:143], a[236:239], v[180:183], a[140:143]
    v_exp_f32 v187, v187
    s_waitcnt lgkmcnt(4)
    v_mfma_f32_16x16x32_bf16 a[16:19], a[240:243], v[172:175], a[16:19]
    ds_read_b64_tr_b16 a[252:253], v233 offset:49152
    ds_read_b64_tr_b16 a[254:255], v233 offset:57344
    v_mfma_f32_16x16x32_bf16 a[80:83], a[240:243], v[176:179], a[80:83]
    v_fma_f32 v188, v120, s21, -v217
    buffer_load_dwordx4 v237, s[8:11], s24 offen offset:3072 lds
    v_mfma_f32_16x16x32_bf16 a[144:147], a[240:243], v[180:183], a[144:147]
    v_exp_f32 v188, v188
    s_waitcnt lgkmcnt(4)
    v_mfma_f32_16x16x32_bf16 a[20:23], a[244:247], v[172:175], a[20:23]
    ds_read_b64_tr_b16 a[224:225], v226 offset:49408
    ds_read_b64_tr_b16 a[226:227], v226 offset:57600
    v_mfma_f32_16x16x32_bf16 a[84:87], a[244:247], v[176:179], a[84:87]
    v_fma_f32 v189, v121, s21, -v217
    s_add_u32 s24, s24, 16384
    v_mfma_f32_16x16x32_bf16 a[148:151], a[244:247], v[180:183], a[148:151]
    v_exp_f32 v189, v189
    s_waitcnt lgkmcnt(4)
    v_mfma_f32_16x16x32_bf16 a[24:27], a[248:251], v[172:175], a[24:27]
    ds_read_b64_tr_b16 a[228:229], v227 offset:49408
    ds_read_b64_tr_b16 a[230:231], v227 offset:57600
    v_mfma_f32_16x16x32_bf16 a[88:91], a[248:251], v[176:179], a[88:91]
    v_fma_f32 v190, v122, s21, -v217
    s_add_u32 m0, s23, 98304
    v_mfma_f32_16x16x32_bf16 a[152:155], a[248:251], v[180:183], a[152:155]
    v_exp_f32 v190, v190
    s_waitcnt lgkmcnt(4)
    v_mfma_f32_16x16x32_bf16 a[28:31], a[252:255], v[172:175], a[28:31]
    ds_read_b64_tr_b16 a[232:233], v228 offset:49408
    ds_read_b64_tr_b16 a[234:235], v228 offset:57600
    v_mfma_f32_16x16x32_bf16 a[92:95], a[252:255], v[176:179], a[92:95]
    v_fma_f32 v191, v123, s21, -v217
    buffer_load_dwordx4 v238, s[12:15], s25 offen offset:0 lds
    v_mfma_f32_16x16x32_bf16 a[156:159], a[252:255], v[180:183], a[156:159]
    v_exp_f32 v191, v191
    s_waitcnt lgkmcnt(4)
    v_mfma_f32_16x16x32_bf16 a[32:35], a[224:227], v[172:175], a[32:35]
    ds_read_b64_tr_b16 a[236:237], v229 offset:49408
    ds_read_b64_tr_b16 a[238:239], v229 offset:57600
    v_mfma_f32_16x16x32_bf16 a[96:99], a[224:227], v[176:179], a[96:99]
    v_fma_f32 v192, v116, s21, -v216
    buffer_load_dwordx4 v239, s[12:15], s25 offen offset:1024 lds
    v_mfma_f32_16x16x32_bf16 a[160:163], a[224:227], v[180:183], a[160:163]
    v_exp_f32 v192, v192
    s_waitcnt lgkmcnt(4)
    v_mfma_f32_16x16x32_bf16 a[36:39], a[228:231], v[172:175], a[36:39]
    ds_read_b64_tr_b16 a[240:241], v230 offset:49408
    ds_read_b64_tr_b16 a[242:243], v230 offset:57600
    v_mfma_f32_16x16x32_bf16 a[100:103], a[228:231], v[176:179], a[100:103]
    v_fma_f32 v193, v117, s21, -v216
    buffer_load_dwordx4 v240, s[12:15], s25 offen offset:2048 lds
    v_mfma_f32_16x16x32_bf16 a[164:167], a[228:231], v[180:183], a[164:167]
    v_exp_f32 v193, v193
    s_waitcnt lgkmcnt(4)
    v_mfma_f32_16x16x32_bf16 a[40:43], a[232:235], v[172:175], a[40:43]
    ds_read_b64_tr_b16 a[244:245], v231 offset:49408
    ds_read_b64_tr_b16 a[246:247], v231 offset:57600
    v_mfma_f32_16x16x32_bf16 a[104:107], a[232:235], v[176:179], a[104:107]
    v_fma_f32 v194, v118, s21, -v216
    buffer_load_dwordx4 v241, s[12:15], s25 offen offset:3072 lds
    v_mfma_f32_16x16x32_bf16 a[168:171], a[232:235], v[180:183], a[168:171]
    v_exp_f32 v194, v194
    s_waitcnt lgkmcnt(4)
    v_mfma_f32_16x16x32_bf16 a[44:47], a[236:239], v[172:175], a[44:47]
    ds_read_b64_tr_b16 a[248:249], v232 offset:49408
    ds_read_b64_tr_b16 a[250:251], v232 offset:57600
    v_mfma_f32_16x16x32_bf16 a[108:111], a[236:239], v[176:179], a[108:111]
    v_fma_f32 v195, v119, s21, -v216
    s_add_u32 s25, s25, 16384
    v_mfma_f32_16x16x32_bf16 a[172:175], a[236:239], v[180:183], a[172:175]
    v_exp_f32 v195, v195
    s_waitcnt lgkmcnt(4)
    v_mfma_f32_16x16x32_bf16 a[48:51], a[240:243], v[172:175], a[48:51]
    ds_read_b64_tr_b16 a[252:253], v233 offset:49408
    ds_read_b64_tr_b16 a[254:255], v233 offset:57600
    v_mfma_f32_16x16x32_bf16 a[112:115], a[240:243], v[176:179], a[112:115]
    v_fma_f32 v196, v124, s21, -v217
    ds_read_b128 a[192:195], v222 offset:16384
    v_mfma_f32_16x16x32_bf16 a[176:179], a[240:243], v[180:183], a[176:179]
    v_exp_f32 v196, v196
    s_waitcnt lgkmcnt(5)
    v_mfma_f32_16x16x32_bf16 a[52:55], a[244:247], v[172:175], a[52:55]
    v_fma_f32 v197, v125, s21, -v217
    ds_read_b128 a[196:199], v223 offset:16384
    v_mfma_f32_16x16x32_bf16 a[116:119], a[244:247], v[176:179], a[116:119]
    v_exp_f32 v197, v197
    v_mfma_f32_16x16x32_bf16 a[180:183], a[244:247], v[180:183], a[180:183]
    v_fma_f32 v198, v126, s21, -v217
    ds_read_b128 a[200:203], v224 offset:16384
    s_waitcnt lgkmcnt(5)
    v_mfma_f32_16x16x32_bf16 a[56:59], a[248:251], v[172:175], a[56:59]
    v_exp_f32 v198, v198
    v_mfma_f32_16x16x32_bf16 a[120:123], a[248:251], v[176:179], a[120:123]
    v_fma_f32 v199, v127, s21, -v217
    v_mfma_f32_16x16x32_bf16 a[184:187], a[248:251], v[180:183], a[184:187]
    v_exp_f32 v199, v199
    s_waitcnt lgkmcnt(3)
    v_mfma_f32_16x16x32_bf16 a[60:63], a[252:255], v[172:175], a[60:63]
    v_mfma_f32_16x16x32_bf16 a[124:127], a[252:255], v[176:179], a[124:127]
    v_mfma_f32_16x16x32_bf16 a[188:191], a[252:255], v[180:183], a[188:191]
    s_add_u32 s26, s26, 1
    s_cmp_lt_u32 s26, 7
    s_cbranch_scc1 L_loop
    s_waitcnt lgkmcnt(2)
    v_mfma_f32_16x16x32_bf16 v[136:139], a[192:195], v[16:19], 0
    ds_read_b128 a[204:207], v225 offset:16384
    v_fma_f32 v242, v128, s21, -v218
    v_mfma_f32_16x16x32_bf16 v[144:147], a[192:195], v[48:51], 0
    v_exp_f32 v242, v242
    v_mfma_f32_16x16x32_bf16 v[152:155], a[192:195], v[80:83], 0
    v_fma_f32 v243, v129, s21, -v218
    s_waitcnt lgkmcnt(2)
    v_mfma_f32_16x16x32_bf16 v[136:139], a[196:199], v[20:23], v[136:139]
    ds_read_b128 a[208:211], v222 offset:16640
    v_mfma_f32_16x16x32_bf16 v[144:147], a[196:199], v[52:55], v[144:147]
    v_exp_f32 v243, v243
    v_mfma_f32_16x16x32_bf16 v[152:155], a[196:199], v[84:87], v[152:155]
    v_fma_f32 v244, v130, s21, -v218
    s_waitcnt lgkmcnt(2)
    v_mfma_f32_16x16x32_bf16 v[136:139], a[200:203], v[24:27], v[136:139]
    ds_read_b128 a[212:215], v223 offset:16640
    v_mfma_f32_16x16x32_bf16 v[144:147], a[200:203], v[56:59], v[144:147]
    v_exp_f32 v244, v244
    v_mfma_f32_16x16x32_bf16 v[152:155], a[200:203], v[88:91], v[152:155]
    v_fma_f32 v245, v131, s21, -v218
    s_waitcnt lgkmcnt(2)
    v_mfma_f32_16x16x32_bf16 v[136:139], a[204:207], v[28:31], v[136:139]
    ds_read_b128 a[216:219], v224 offset:16640
    v_mfma_f32_16x16x32_bf16 v[144:147], a[204:207], v[60:63], v[144:147]
    v_exp_f32 v245, v245
    v_mfma_f32_16x16x32_bf16 v[152:155], a[204:207], v[92:95], v[152:155]
    v_fma_f32 v246, v132, s21, -v218
    s_waitcnt lgkmcnt(2)
    v_mfma_f32_16x16x32_bf16 v[136:139], a[208:211], v[32:35], v[136:139]
    ds_read_b128 a[220:223], v225 offset:16640
    v_mfma_f32_16x16x32_bf16 v[144:147], a[208:211], v[64:67], v[144:147]
    v_exp_f32 v246, v246
    v_mfma_f32_16x16x32_bf16 v[152:155], a[208:211], v[96:99], v[152:155]
    v_fma_f32 v247, v133, s21, -v218
    s_waitcnt lgkmcnt(2)
    v_mfma_f32_16x16x32_bf16 v[136:139], a[212:215], v[36:39], v[136:139]
    ds_read_b128 a[192:195], v222 offset:24576
    v_mfma_f32_16x16x32_bf16 v[144:147], a[212:215], v[68:71], v[144:147]
    v_exp_f32 v247, v247
    v_mfma_f32_16x16x32_bf16 v[152:155], a[212:215], v[100:103], v[152:155]
    v_fma_f32 v248, v134, s21, -v218
    s_waitcnt lgkmcnt(2)
    v_mfma_f32_16x16x32_bf16 v[136:139], a[216:219], v[40:43], v[136:139]
    ds_read_b128 a[196:199], v223 offset:24576
    v_mfma_f32_16x16x32_bf16 v[144:147], a[216:219], v[72:75], v[144:147]
    v_exp_f32 v248, v248
    v_mfma_f32_16x16x32_bf16 v[152:155], a[216:219], v[104:107], v[152:155]
    v_fma_f32 v249, v135, s21, -v218
    s_waitcnt lgkmcnt(2)
    v_mfma_f32_16x16x32_bf16 v[136:139], a[220:223], v[44:47], v[136:139]
    ds_read_b128 a[200:203], v224 offset:24576
    v_mfma_f32_16x16x32_bf16 v[144:147], a[220:223], v[76:79], v[144:147]
    v_exp_f32 v249, v249
    v_mfma_f32_16x16x32_bf16 v[152:155], a[220:223], v[108:111], v[152:155]
    v_cvt_pk_bf16_f32 v160, v184, v185
    v_cvt_pk_bf16_f32 v161, v186, v187
    s_waitcnt lgkmcnt(2)
    v_mfma_f32_16x16x32_bf16 v[140:143], a[192:195], v[16:19], 0
    ds_read_b128 a[204:207], v225 offset:24576
    v_cvt_pk_bf16_f32 v164, v188, v189
    v_mfma_f32_16x16x32_bf16 v[148:151], a[192:195], v[48:51], 0
    v_cvt_pk_bf16_f32 v165, v190, v191
    v_cvt_pk_bf16_f32 v162, v192, v193
    v_mfma_f32_16x16x32_bf16 v[156:159], a[192:195], v[80:83], 0
    v_cvt_pk_bf16_f32 v163, v194, v195
    v_cvt_pk_bf16_f32 v166, v196, v197
    s_waitcnt lgkmcnt(2)
    v_mfma_f32_16x16x32_bf16 v[140:143], a[196:199], v[20:23], v[140:143]
    ds_read_b128 a[208:211], v222 offset:24832
    v_cvt_pk_bf16_f32 v167, v198, v199
    v_mfma_f32_16x16x32_bf16 v[148:151], a[196:199], v[52:55], v[148:151]
    v_cvt_pk_bf16_f32 v168, v242, v243
    v_cvt_pk_bf16_f32 v169, v244, v245
    v_mfma_f32_16x16x32_bf16 v[156:159], a[196:199], v[84:87], v[156:159]
    v_cvt_pk_bf16_f32 v170, v246, v247
    v_cvt_pk_bf16_f32 v171, v248, v249
    s_waitcnt lgkmcnt(2)
    v_mfma_f32_16x16x32_bf16 v[140:143], a[200:203], v[24:27], v[140:143]
    ds_read_b128 a[212:215], v223 offset:24832
    v_mfma_f32_16x16x32_bf16 v[148:151], a[200:203], v[56:59], v[148:151]
    v_mfma_f32_16x16x32_bf16 v[156:159], a[200:203], v[88:91], v[156:159]
    s_waitcnt lgkmcnt(2)
    v_mfma_f32_16x16x32_bf16 v[140:143], a[204:207], v[28:31], v[140:143]
    ds_read_b128 a[216:219], v224 offset:24832
    v_mfma_f32_16x16x32_bf16 v[148:151], a[204:207], v[60:63], v[148:151]
    v_mfma_f32_16x16x32_bf16 v[156:159], a[204:207], v[92:95], v[156:159]
    v_mfma_f32_16x16x32_bf16 v[200:203], v[212:215], v[160:163], 0
    ds_read_b128 a[220:223], v225 offset:24832
    ds_read_b64_tr_b16 a[224:225], v226 offset:0
    v_mfma_f32_16x16x32_bf16 v[204:207], v[212:215], v[164:167], 0
    ds_read_b64_tr_b16 a[226:227], v226 offset:8192
    ds_read_b64_tr_b16 a[228:229], v227 offset:0
    v_mfma_f32_16x16x32_bf16 v[208:211], v[212:215], v[168:171], 0
    ds_read_b64_tr_b16 a[230:231], v227 offset:8192
    ds_read_b64_tr_b16 a[232:233], v228 offset:0
    s_waitcnt lgkmcnt(8)
    v_mfma_f32_16x16x32_bf16 v[140:143], a[208:211], v[32:35], v[140:143]
    ds_read_b64_tr_b16 a[234:235], v228 offset:8192
    v_mfma_f32_16x16x32_bf16 v[148:151], a[208:211], v[64:67], v[148:151]
    v_mfma_f32_16x16x32_bf16 v[156:159], a[208:211], v[96:99], v[156:159]
    s_waitcnt lgkmcnt(8)
    v_mfma_f32_16x16x32_bf16 v[140:143], a[212:215], v[36:39], v[140:143]
    v_mfma_f32_16x16x32_bf16 v[148:151], a[212:215], v[68:71], v[148:151]
    v_mfma_f32_16x16x32_bf16 v[156:159], a[212:215], v[100:103], v[156:159]
    s_waitcnt lgkmcnt(7)
    v_mfma_f32_16x16x32_bf16 v[140:143], a[216:219], v[40:43], v[140:143]
    v_mfma_f32_16x16x32_bf16 v[148:151], a[216:219], v[72:75], v[148:151]
    v_mfma_f32_16x16x32_bf16 v[156:159], a[216:219], v[104:107], v[156:159]
    s_waitcnt lgkmcnt(6)
    v_mfma_f32_16x16x32_bf16 v[140:143], a[220:223], v[44:47], v[140:143]
    v_mfma_f32_16x16x32_bf16 v[148:151], a[220:223], v[76:79], v[148:151]
    v_mfma_f32_16x16x32_bf16 v[156:159], a[220:223], v[108:111], v[156:159]
    v_max3_f32 v250, v200, v204, v208
    v_cmp_nle_f32 vcc, v250, s22
    s_cbranch_vccz L_ok_4
    s_swappc_b64 s[44:45], s[40:41]
L_ok_4:
    v_add_f32 v219, v219, v200
    v_add_f32 v220, v220, v204
    v_add_f32 v221, v221, v208
    s_waitcnt vmcnt(8)
    s_barrier
    s_waitcnt lgkmcnt(4)
    v_mfma_f32_16x16x32_bf16 a[0:3], a[224:227], v[160:163], a[0:3]
    ds_read_b64_tr_b16 a[236:237], v229 offset:0
    ds_read_b64_tr_b16 a[238:239], v229 offset:8192
    v_mfma_f32_16x16x32_bf16 a[64:67], a[224:227], v[164:167], a[64:67]
    v_fma_f32 v184, v136, s21, -v216
    s_add_u32 m0, s23, 114688
    v_mfma_f32_16x16x32_bf16 a[128:131], a[224:227], v[168:171], a[128:131]
    v_exp_f32 v184, v184
    s_waitcnt lgkmcnt(4)
    v_mfma_f32_16x16x32_bf16 a[4:7], a[228:231], v[160:163], a[4:7]
    ds_read_b64_tr_b16 a[240:241], v230 offset:0
    ds_read_b64_tr_b16 a[242:243], v230 offset:8192
    v_mfma_f32_16x16x32_bf16 a[68:71], a[228:231], v[164:167], a[68:71]
    v_fma_f32 v185, v137, s21, -v216
    buffer_load_dwordx4 v238, s[12:15], s25 offen offset:0 lds
    v_mfma_f32_16x16x32_bf16 a[132:135], a[228:231], v[168:171], a[132:135]
    v_exp_f32 v185, v185
    s_waitcnt lgkmcnt(4)
    v_mfma_f32_16x16x32_bf16 a[8:11], a[232:235], v[160:163], a[8:11]
    ds_read_b64_tr_b16 a[244:245], v231 offset:0
    ds_read_b64_tr_b16 a[246:247], v231 offset:8192
    v_mfma_f32_16x16x32_bf16 a[72:75], a[232:235], v[164:167], a[72:75]
    v_fma_f32 v186, v138, s21, -v216
    buffer_load_dwordx4 v239, s[12:15], s25 offen offset:1024 lds
    v_mfma_f32_16x16x32_bf16 a[136:139], a[232:235], v[168:171], a[136:139]
    v_exp_f32 v186, v186
    s_waitcnt lgkmcnt(4)
    v_mfma_f32_16x16x32_bf16 a[12:15], a[236:239], v[160:163], a[12:15]
    ds_read_b64_tr_b16 a[248:249], v232 offset:0
    ds_read_b64_tr_b16 a[250:251], v232 offset:8192
    v_mfma_f32_16x16x32_bf16 a[76:79], a[236:239], v[164:167], a[76:79]
    v_fma_f32 v187, v139, s21, -v216
    buffer_load_dwordx4 v240, s[12:15], s25 offen offset:2048 lds
    v_mfma_f32_16x16x32_bf16 a[140:143], a[236:239], v[168:171], a[140:143]
    v_exp_f32 v187, v187
    s_waitcnt lgkmcnt(4)
    v_mfma_f32_16x16x32_bf16 a[16:19], a[240:243], v[160:163], a[16:19]
    ds_read_b64_tr_b16 a[252:253], v233 offset:0
    ds_read_b64_tr_b16 a[254:255], v233 offset:8192
    v_mfma_f32_16x16x32_bf16 a[80:83], a[240:243], v[164:167], a[80:83]
    v_fma_f32 v188, v144, s21, -v217
    buffer_load_dwordx4 v241, s[12:15], s25 offen offset:3072 lds
    v_mfma_f32_16x16x32_bf16 a[144:147], a[240:243], v[168:171], a[144:147]
    v_exp_f32 v188, v188
    s_waitcnt lgkmcnt(4)
    v_mfma_f32_16x16x32_bf16 a[20:23], a[244:247], v[160:163], a[20:23]
    ds_read_b64_tr_b16 a[224:225], v226 offset:256
    ds_read_b64_tr_b16 a[226:227], v226 offset:8448
    v_mfma_f32_16x16x32_bf16 a[84:87], a[244:247], v[164:167], a[84:87]
    v_fma_f32 v189, v145, s21, -v217
    s_add_u32 s25, s25, 16384
    v_mfma_f32_16x16x32_bf16 a[148:151], a[244:247], v[168:171], a[148:151]
    v_exp_f32 v189, v189
    s_waitcnt lgkmcnt(4)
    v_mfma_f32_16x16x32_bf16 a[24:27], a[248:251], v[160:163], a[24:27]
    ds_read_b64_tr_b16 a[228:229], v227 offset:256
    ds_read_b64_tr_b16 a[230:231], v227 offset:8448
    v_mfma_f32_16x16x32_bf16 a[88:91], a[248:251], v[164:167], a[88:91]
    v_fma_f32 v190, v146, s21, -v217
    v_mfma_f32_16x16x32_bf16 a[152:155], a[248:251], v[168:171], a[152:155]
    v_exp_f32 v190, v190
    s_waitcnt lgkmcnt(4)
    v_mfma_f32_16x16x32_bf16 a[28:31], a[252:255], v[160:163], a[28:31]
    ds_read_b64_tr_b16 a[232:233], v228 offset:256
    ds_read_b64_tr_b16 a[234:235], v228 offset:8448
    v_mfma_f32_16x16x32_bf16 a[92:95], a[252:255], v[164:167], a[92:95]
    v_fma_f32 v191, v147, s21, -v217
    v_mfma_f32_16x16x32_bf16 a[156:159], a[252:255], v[168:171], a[156:159]
    v_exp_f32 v191, v191
    s_waitcnt lgkmcnt(4)
    v_mfma_f32_16x16x32_bf16 a[32:35], a[224:227], v[160:163], a[32:35]
    ds_read_b64_tr_b16 a[236:237], v229 offset:256
    ds_read_b64_tr_b16 a[238:239], v229 offset:8448
    v_mfma_f32_16x16x32_bf16 a[96:99], a[224:227], v[164:167], a[96:99]
    v_fma_f32 v192, v140, s21, -v216
    v_mfma_f32_16x16x32_bf16 a[160:163], a[224:227], v[168:171], a[160:163]
    v_exp_f32 v192, v192
    s_waitcnt lgkmcnt(4)
    v_mfma_f32_16x16x32_bf16 a[36:39], a[228:231], v[160:163], a[36:39]
    ds_read_b64_tr_b16 a[240:241], v230 offset:256
    ds_read_b64_tr_b16 a[242:243], v230 offset:8448
    v_mfma_f32_16x16x32_bf16 a[100:103], a[228:231], v[164:167], a[100:103]
    v_fma_f32 v193, v141, s21, -v216
    v_mfma_f32_16x16x32_bf16 a[164:167], a[228:231], v[168:171], a[164:167]
    v_exp_f32 v193, v193
    s_waitcnt lgkmcnt(4)
    v_mfma_f32_16x16x32_bf16 a[40:43], a[232:235], v[160:163], a[40:43]
    ds_read_b64_tr_b16 a[244:245], v231 offset:256
    ds_read_b64_tr_b16 a[246:247], v231 offset:8448
    v_mfma_f32_16x16x32_bf16 a[104:107], a[232:235], v[164:167], a[104:107]
    v_fma_f32 v194, v142, s21, -v216
    v_mfma_f32_16x16x32_bf16 a[168:171], a[232:235], v[168:171], a[168:171]
    v_exp_f32 v194, v194
    s_waitcnt lgkmcnt(4)
    v_mfma_f32_16x16x32_bf16 a[44:47], a[236:239], v[160:163], a[44:47]
    ds_read_b64_tr_b16 a[248:249], v232 offset:256
    ds_read_b64_tr_b16 a[250:251], v232 offset:8448
    v_mfma_f32_16x16x32_bf16 a[108:111], a[236:239], v[164:167], a[108:111]
    v_fma_f32 v195, v143, s21, -v216
    v_mfma_f32_16x16x32_bf16 a[172:175], a[236:239], v[168:171], a[172:175]
    v_exp_f32 v195, v195
    s_waitcnt lgkmcnt(4)
    v_mfma_f32_16x16x32_bf16 a[48:51], a[240:243], v[160:163], a[48:51]
    ds_read_b64_tr_b16 a[252:253], v233 offset:256
    ds_read_b64_tr_b16 a[254:255], v233 offset:8448
    v_mfma_f32_16x16x32_bf16 a[112:115], a[240:243], v[164:167], a[112:115]
    v_fma_f32 v196, v148, s21, -v217
    ds_read_b128 a[192:195], v222 offset:32768
    v_mfma_f32_16x16x32_bf16 a[176:179], a[240:243], v[168:171], a[176:179]
    v_exp_f32 v196, v196
    s_waitcnt lgkmcnt(5)
    v_mfma_f32_16x16x32_bf16 a[52:55], a[244:247], v[160:163], a[52:55]
    v_fma_f32 v197, v149, s21, -v217
    ds_read_b128 a[196:199], v223 offset:32768
    v_mfma_f32_16x16x32_bf16 a[116:119], a[244:247], v[164:167], a[116:119]
    v_exp_f32 v197, v197
    v_mfma_f32_16x16x32_bf16 a[180:183], a[244:247], v[168:171], a[180:183]
    v_fma_f32 v198, v150, s21, -v217
    ds_read_b128 a[200:203], v224 offset:32768
    s_waitcnt lgkmcnt(5)
    v_mfma_f32_16x16x32_bf16 a[56:59], a[248:251], v[160:163], a[56:59]
    v_exp_f32 v198, v198
    v_mfma_f32_16x16x32_bf16 a[120:123], a[248:251], v[164:167], a[120:123]
    v_fma_f32 v199, v151, s21, -v217
    v_mfma_f32_16x16x32_bf16 a[184:187], a[248:251], v[168:171], a[184:187]
    v_exp_f32 v199, v199
    s_waitcnt lgkmcnt(3)
    v_mfma_f32_16x16x32_bf16 a[60:63], a[252:255], v[160:163], a[60:63]
    v_mfma_f32_16x16x32_bf16 a[124:127], a[252:255], v[164:167], a[124:127]
    v_mfma_f32_16x16x32_bf16 a[188:191], a[252:255], v[168:171], a[188:191]
    s_waitcnt lgkmcnt(2)
    v_mfma_f32_16x16x32_bf16 v[112:115], a[192:195], v[16:19], 0
    ds_read_b128 a[204:207], v225 offset:32768
    v_fma_f32 v242, v152, s21, -v218
    v_mfma_f32_16x16x32_bf16 v[120:123], a[192:195], v[48:51], 0
    v_exp_f32 v242, v242
    v_mfma_f32_16x16x32_bf16 v[128:131], a[192:195], v[80:83], 0
    v_fma_f32 v243, v153, s21, -v218
    s_waitcnt lgkmcnt(2)
    v_mfma_f32_16x16x32_bf16 v[112:115], a[196:199], v[20:23], v[112:115]
    ds_read_b128 a[208:211], v222 offset:33024
    v_mfma_f32_16x16x32_bf16 v[120:123], a[196:199], v[52:55], v[120:123]
    v_exp_f32 v243, v243
    v_mfma_f32_16x16x32_bf16 v[128:131], a[196:199], v[84:87], v[128:131]
    v_fma_f32 v244, v154, s21, -v218
    s_waitcnt lgkmcnt(2)
    v_mfma_f32_16x16x32_bf16 v[112:115], a[200:203], v[24:27], v[112:115]
    ds_read_b128 a[212:215], v223 offset:33024
    v_mfma_f32_16x16x32_bf16 v[120:123], a[200:203], v[56:59], v[120:123]
    v_exp_f32 v244, v244
    v_mfma_f32_16x16x32_bf16 v[128:131], a[200:203], v[88:91], v[128:131]
    v_fma_f32 v245, v155, s21, -v218
    s_waitcnt lgkmcnt(2)
    v_mfma_f32_16x16x32_bf16 v[112:115], a[204:207], v[28:31], v[112:115]
    ds_read_b128 a[216:219], v224 offset:33024
    v_mfma_f32_16x16x32_bf16 v[120:123], a[204:207], v[60:63], v[120:123]
    v_exp_f32 v245, v245
    v_mfma_f32_16x16x32_bf16 v[128:131], a[204:207], v[92:95], v[128:131]
    v_fma_f32 v246, v156, s21, -v218
    s_waitcnt lgkmcnt(2)
    v_mfma_f32_16x16x32_bf16 v[112:115], a[208:211], v[32:35], v[112:115]
    ds_read_b128 a[220:223], v225 offset:33024
    v_mfma_f32_16x16x32_bf16 v[120:123], a[208:211], v[64:67], v[120:123]
    v_exp_f32 v246, v246
    v_mfma_f32_16x16x32_bf16 v[128:131], a[208:211], v[96:99], v[128:131]
    v_fma_f32 v247, v157, s21, -v218
    s_waitcnt lgkmcnt(2)
    v_mfma_f32_16x16x32_bf16 v[112:115], a[212:215], v[36:39], v[112:115]
    ds_read_b128 a[192:195], v222 offset:40960
    v_mfma_f32_16x16x32_bf16 v[120:123], a[212:215], v[68:71], v[120:123]
    v_exp_f32 v247, v247
    v_mfma_f32_16x16x32_bf16 v[128:131], a[212:215], v[100:103], v[128:131]
    v_fma_f32 v248, v158, s21, -v218
    s_waitcnt lgkmcnt(2)
    v_mfma_f32_16x16x32_bf16 v[112:115], a[216:219], v[40:43], v[112:115]
    ds_read_b128 a[196:199], v223 offset:40960
    v_mfma_f32_16x16x32_bf16 v[120:123], a[216:219], v[72:75], v[120:123]
    v_exp_f32 v248, v248
    v_mfma_f32_16x16x32_bf16 v[128:131], a[216:219], v[104:107], v[128:131]
    v_fma_f32 v249, v159, s21, -v218
    s_waitcnt lgkmcnt(2)
    v_mfma_f32_16x16x32_bf16 v[112:115], a[220:223], v[44:47], v[112:115]
    ds_read_b128 a[200:203], v224 offset:40960
    v_mfma_f32_16x16x32_bf16 v[120:123], a[220:223], v[76:79], v[120:123]
    v_exp_f32 v249, v249
    v_mfma_f32_16x16x32_bf16 v[128:131], a[220:223], v[108:111], v[128:131]
    v_cvt_pk_bf16_f32 v172, v184, v185
    v_cvt_pk_bf16_f32 v173, v186, v187
    s_waitcnt lgkmcnt(2)
    v_mfma_f32_16x16x32_bf16 v[116:119], a[192:195], v[16:19], 0
    ds_read_b128 a[204:207], v225 offset:40960
    v_cvt_pk_bf16_f32 v176, v188, v189
    v_mfma_f32_16x16x32_bf16 v[124:127], a[192:195], v[48:51], 0
    v_cvt_pk_bf16_f32 v177, v190, v191
    v_cvt_pk_bf16_f32 v174, v192, v193
    v_mfma_f32_16x16x32_bf16 v[132:135], a[192:195], v[80:83], 0
    v_cvt_pk_bf16_f32 v175, v194, v195
    v_cvt_pk_bf16_f32 v178, v196, v197
    s_waitcnt lgkmcnt(2)
    v_mfma_f32_16x16x32_bf16 v[116:119], a[196:199], v[20:23], v[116:119]
    ds_read_b128 a[208:211], v222 offset:41216
    v_cvt_pk_bf16_f32 v179, v198, v199
    v_mfma_f32_16x16x32_bf16 v[124:127], a[196:199], v[52:55], v[124:127]
    v_cvt_pk_bf16_f32 v180, v242, v243
    v_cvt_pk_bf16_f32 v181, v244, v245
    v_mfma_f32_16x16x32_bf16 v[132:135], a[196:199], v[84:87], v[132:135]
    v_cvt_pk_bf16_f32 v182, v246, v247
    v_cvt_pk_bf16_f32 v183, v248, v249
    s_waitcnt lgkmcnt(2)
    v_mfma_f32_16x16x32_bf16 v[116:119], a[200:203], v[24:27], v[116:119]
    ds_read_b128 a[212:215], v223 offset:41216
    v_mfma_f32_16x16x32_bf16 v[124:127], a[200:203], v[56:59], v[124:127]
    v_mfma_f32_16x16x32_bf16 v[132:135], a[200:203], v[88:91], v[132:135]
    s_waitcnt lgkmcnt(2)
    v_mfma_f32_16x16x32_bf16 v[116:119], a[204:207], v[28:31], v[116:119]
    ds_read_b128 a[216:219], v224 offset:41216
    v_mfma_f32_16x16x32_bf16 v[124:127], a[204:207], v[60:63], v[124:127]
    v_mfma_f32_16x16x32_bf16 v[132:135], a[204:207], v[92:95], v[132:135]
    v_mfma_f32_16x16x32_bf16 v[200:203], v[212:215], v[172:175], 0
    ds_read_b128 a[220:223], v225 offset:41216
    ds_read_b64_tr_b16 a[224:225], v226 offset:16384
    v_mfma_f32_16x16x32_bf16 v[204:207], v[212:215], v[176:179], 0
    ds_read_b64_tr_b16 a[226:227], v226 offset:24576
    ds_read_b64_tr_b16 a[228:229], v227 offset:16384
    v_mfma_f32_16x16x32_bf16 v[208:211], v[212:215], v[180:183], 0
    ds_read_b64_tr_b16 a[230:231], v227 offset:24576
    ds_read_b64_tr_b16 a[232:233], v228 offset:16384
    s_waitcnt lgkmcnt(8)
    v_mfma_f32_16x16x32_bf16 v[116:119], a[208:211], v[32:35], v[116:119]
    ds_read_b64_tr_b16 a[234:235], v228 offset:24576
    v_mfma_f32_16x16x32_bf16 v[124:127], a[208:211], v[64:67], v[124:127]
    v_mfma_f32_16x16x32_bf16 v[132:135], a[208:211], v[96:99], v[132:135]
    s_waitcnt lgkmcnt(8)
    v_mfma_f32_16x16x32_bf16 v[116:119], a[212:215], v[36:39], v[116:119]
    v_mfma_f32_16x16x32_bf16 v[124:127], a[212:215], v[68:71], v[124:127]
    v_mfma_f32_16x16x32_bf16 v[132:135], a[212:215], v[100:103], v[132:135]
    s_waitcnt lgkmcnt(7)
    v_mfma_f32_16x16x32_bf16 v[116:119], a[216:219], v[40:43], v[116:119]
    v_mfma_f32_16x16x32_bf16 v[124:127], a[216:219], v[72:75], v[124:127]
    v_mfma_f32_16x16x32_bf16 v[132:135], a[216:219], v[104:107], v[132:135]
    s_waitcnt lgkmcnt(6)
    v_mfma_f32_16x16x32_bf16 v[116:119], a[220:223], v[44:47], v[116:119]
    v_mfma_f32_16x16x32_bf16 v[124:127], a[220:223], v[76:79], v[124:127]
    v_mfma_f32_16x16x32_bf16 v[132:135], a[220:223], v[108:111], v[132:135]
    v_max3_f32 v250, v200, v204, v208
    v_cmp_nle_f32 vcc, v250, s22
    s_cbranch_vccz L_ok_5
    s_swappc_b64 s[44:45], s[42:43]
L_ok_5:
    v_add_f32 v219, v219, v200
    v_add_f32 v220, v220, v204
    v_add_f32 v221, v221, v208
    s_waitcnt vmcnt(4)
    s_barrier
    s_waitcnt lgkmcnt(4)
    v_mfma_f32_16x16x32_bf16 a[0:3], a[224:227], v[172:175], a[0:3]
    ds_read_b64_tr_b16 a[236:237], v229 offset:16384
    ds_read_b64_tr_b16 a[238:239], v229 offset:24576
    v_mfma_f32_16x16x32_bf16 a[64:67], a[224:227], v[176:179], a[64:67]
    v_fma_f32 v184, v112, s21, -v216
    v_mfma_f32_16x16x32_bf16 a[128:131], a[224:227], v[180:183], a[128:131]
    v_exp_f32 v184, v184
    s_waitcnt lgkmcnt(4)
    v_mfma_f32_16x16x32_bf16 a[4:7], a[228:231], v[172:175], a[4:7]
    ds_read_b64_tr_b16 a[240:241], v230 offset:16384
    ds_read_b64_tr_b16 a[242:243], v230 offset:24576
    v_mfma_f32_16x16x32_bf16 a[68:71], a[228:231], v[176:179], a[68:71]
    v_fma_f32 v185, v113, s21, -v216
    v_mfma_f32_16x16x32_bf16 a[132:135], a[228:231], v[180:183], a[132:135]
    v_exp_f32 v185, v185
    s_waitcnt lgkmcnt(4)
    v_mfma_f32_16x16x32_bf16 a[8:11], a[232:235], v[172:175], a[8:11]
    ds_read_b64_tr_b16 a[244:245], v231 offset:16384
    ds_read_b64_tr_b16 a[246:247], v231 offset:24576
    v_mfma_f32_16x16x32_bf16 a[72:75], a[232:235], v[176:179], a[72:75]
    v_fma_f32 v186, v114, s21, -v216
    v_mfma_f32_16x16x32_bf16 a[136:139], a[232:235], v[180:183], a[136:139]
    v_exp_f32 v186, v186
    s_waitcnt lgkmcnt(4)
    v_mfma_f32_16x16x32_bf16 a[12:15], a[236:239], v[172:175], a[12:15]
    ds_read_b64_tr_b16 a[248:249], v232 offset:16384
    ds_read_b64_tr_b16 a[250:251], v232 offset:24576
    v_mfma_f32_16x16x32_bf16 a[76:79], a[236:239], v[176:179], a[76:79]
    v_fma_f32 v187, v115, s21, -v216
    v_mfma_f32_16x16x32_bf16 a[140:143], a[236:239], v[180:183], a[140:143]
    v_exp_f32 v187, v187
    s_waitcnt lgkmcnt(4)
    v_mfma_f32_16x16x32_bf16 a[16:19], a[240:243], v[172:175], a[16:19]
    ds_read_b64_tr_b16 a[252:253], v233 offset:16384
    ds_read_b64_tr_b16 a[254:255], v233 offset:24576
    v_mfma_f32_16x16x32_bf16 a[80:83], a[240:243], v[176:179], a[80:83]
    v_fma_f32 v188, v120, s21, -v217
    v_mfma_f32_16x16x32_bf16 a[144:147], a[240:243], v[180:183], a[144:147]
    v_exp_f32 v188, v188
    s_waitcnt lgkmcnt(4)
    v_mfma_f32_16x16x32_bf16 a[20:23], a[244:247], v[172:175], a[20:23]
    ds_read_b64_tr_b16 a[224:225], v226 offset:16640
    ds_read_b64_tr_b16 a[226:227], v226 offset:24832
    v_mfma_f32_16x16x32_bf16 a[84:87], a[244:247], v[176:179], a[84:87]
    v_fma_f32 v189, v121, s21, -v217
    v_mfma_f32_16x16x32_bf16 a[148:151], a[244:247], v[180:183], a[148:151]
    v_exp_f32 v189, v189
    s_waitcnt lgkmcnt(4)
    v_mfma_f32_16x16x32_bf16 a[24:27], a[248:251], v[172:175], a[24:27]
    ds_read_b64_tr_b16 a[228:229], v227 offset:16640
    ds_read_b64_tr_b16 a[230:231], v227 offset:24832
    v_mfma_f32_16x16x32_bf16 a[88:91], a[248:251], v[176:179], a[88:91]
    v_fma_f32 v190, v122, s21, -v217
    v_mfma_f32_16x16x32_bf16 a[152:155], a[248:251], v[180:183], a[152:155]
    v_exp_f32 v190, v190
    s_waitcnt lgkmcnt(4)
    v_mfma_f32_16x16x32_bf16 a[28:31], a[252:255], v[172:175], a[28:31]
    ds_read_b64_tr_b16 a[232:233], v228 offset:16640
    ds_read_b64_tr_b16 a[234:235], v228 offset:24832
    v_mfma_f32_16x16x32_bf16 a[92:95], a[252:255], v[176:179], a[92:95]
    v_fma_f32 v191, v123, s21, -v217
    v_mfma_f32_16x16x32_bf16 a[156:159], a[252:255], v[180:183], a[156:159]
    v_exp_f32 v191, v191
    s_waitcnt lgkmcnt(4)
    v_mfma_f32_16x16x32_bf16 a[32:35], a[224:227], v[172:175], a[32:35]
    ds_read_b64_tr_b16 a[236:237], v229 offset:16640
    ds_read_b64_tr_b16 a[238:239], v229 offset:24832
    v_mfma_f32_16x16x32_bf16 a[96:99], a[224:227], v[176:179], a[96:99]
    v_fma_f32 v192, v116, s21, -v216
    v_mfma_f32_16x16x32_bf16 a[160:163], a[224:227], v[180:183], a[160:163]
    v_exp_f32 v192, v192
    s_waitcnt lgkmcnt(4)
    v_mfma_f32_16x16x32_bf16 a[36:39], a[228:231], v[172:175], a[36:39]
    ds_read_b64_tr_b16 a[240:241], v230 offset:16640
    ds_read_b64_tr_b16 a[242:243], v230 offset:24832
    v_mfma_f32_16x16x32_bf16 a[100:103], a[228:231], v[176:179], a[100:103]
    v_fma_f32 v193, v117, s21, -v216
    v_mfma_f32_16x16x32_bf16 a[164:167], a[228:231], v[180:183], a[164:167]
    v_exp_f32 v193, v193
    s_waitcnt lgkmcnt(4)
    v_mfma_f32_16x16x32_bf16 a[40:43], a[232:235], v[172:175], a[40:43]
    ds_read_b64_tr_b16 a[244:245], v231 offset:16640
    ds_read_b64_tr_b16 a[246:247], v231 offset:24832
    v_mfma_f32_16x16x32_bf16 a[104:107], a[232:235], v[176:179], a[104:107]
    v_fma_f32 v194, v118, s21, -v216
    v_mfma_f32_16x16x32_bf16 a[168:171], a[232:235], v[180:183], a[168:171]
    v_exp_f32 v194, v194
    s_waitcnt lgkmcnt(4)
    v_mfma_f32_16x16x32_bf16 a[44:47], a[236:239], v[172:175], a[44:47]
    ds_read_b64_tr_b16 a[248:249], v232 offset:16640
    ds_read_b64_tr_b16 a[250:251], v232 offset:24832
    v_mfma_f32_16x16x32_bf16 a[108:111], a[236:239], v[176:179], a[108:111]
    v_fma_f32 v195, v119, s21, -v216
    v_mfma_f32_16x16x32_bf16 a[172:175], a[236:239], v[180:183], a[172:175]
    v_exp_f32 v195, v195
    s_waitcnt lgkmcnt(4)
    v_mfma_f32_16x16x32_bf16 a[48:51], a[240:243], v[172:175], a[48:51]
    ds_read_b64_tr_b16 a[252:253], v233 offset:16640
    ds_read_b64_tr_b16 a[254:255], v233 offset:24832
    v_mfma_f32_16x16x32_bf16 a[112:115], a[240:243], v[176:179], a[112:115]
    v_fma_f32 v196, v124, s21, -v217
    ds_read_b128 a[192:195], v222 offset:49152
    v_mfma_f32_16x16x32_bf16 a[176:179], a[240:243], v[180:183], a[176:179]
    v_exp_f32 v196, v196
    s_waitcnt lgkmcnt(5)
    v_mfma_f32_16x16x32_bf16 a[52:55], a[244:247], v[172:175], a[52:55]
    v_fma_f32 v197, v125, s21, -v217
    ds_read_b128 a[196:199], v223 offset:49152
    v_mfma_f32_16x16x32_bf16 a[116:119], a[244:247], v[176:179], a[116:119]
    v_exp_f32 v197, v197
    v_mfma_f32_16x16x32_bf16 a[180:183], a[244:247], v[180:183], a[180:183]
    v_fma_f32 v198, v126, s21, -v217
    ds_read_b128 a[200:203], v224 offset:49152
    s_waitcnt lgkmcnt(5)
    v_mfma_f32_16x16x32_bf16 a[56:59], a[248:251], v[172:175], a[56:59]
    v_exp_f32 v198, v198
    v_mfma_f32_16x16x32_bf16 a[120:123], a[248:251], v[176:179], a[120:123]
    v_fma_f32 v199, v127, s21, -v217
    v_mfma_f32_16x16x32_bf16 a[184:187], a[248:251], v[180:183], a[184:187]
    v_exp_f32 v199, v199
    s_waitcnt lgkmcnt(3)
    v_mfma_f32_16x16x32_bf16 a[60:63], a[252:255], v[172:175], a[60:63]
    v_mfma_f32_16x16x32_bf16 a[124:127], a[252:255], v[176:179], a[124:127]
    v_mfma_f32_16x16x32_bf16 a[188:191], a[252:255], v[180:183], a[188:191]
    s_waitcnt lgkmcnt(2)
    v_mfma_f32_16x16x32_bf16 v[136:139], a[192:195], v[16:19], 0
    ds_read_b128 a[204:207], v225 offset:49152
    v_fma_f32 v242, v128, s21, -v218
    v_mfma_f32_16x16x32_bf16 v[144:147], a[192:195], v[48:51], 0
    v_exp_f32 v242, v242
    v_mfma_f32_16x16x32_bf16 v[152:155], a[192:195], v[80:83], 0
    v_fma_f32 v243, v129, s21, -v218
    s_waitcnt lgkmcnt(2)
    v_mfma_f32_16x16x32_bf16 v[136:139], a[196:199], v[20:23], v[136:139]
    ds_read_b128 a[208:211], v222 offset:49408
    v_mfma_f32_16x16x32_bf16 v[144:147], a[196:199], v[52:55], v[144:147]
    v_exp_f32 v243, v243
    v_mfma_f32_16x16x32_bf16 v[152:155], a[196:199], v[84:87], v[152:155]
    v_fma_f32 v244, v130, s21, -v218
    s_waitcnt lgkmcnt(2)
    v_mfma_f32_16x16x32_bf16 v[136:139], a[200:203], v[24:27], v[136:139]
    ds_read_b128 a[212:215], v223 offset:49408
    v_mfma_f32_16x16x32_bf16 v[144:147], a[200:203], v[56:59], v[144:147]
    v_exp_f32 v244, v244
    v_mfma_f32_16x16x32_bf16 v[152:155], a[200:203], v[88:91], v[152:155]
    v_fma_f32 v245, v131, s21, -v218
    s_waitcnt lgkmcnt(2)
    v_mfma_f32_16x16x32_bf16 v[136:139], a[204:207], v[28:31], v[136:139]
    ds_read_b128 a[216:219], v224 offset:49408
    v_mfma_f32_16x16x32_bf16 v[144:147], a[204:207], v[60:63], v[144:147]
    v_exp_f32 v245, v245
    v_mfma_f32_16x16x32_bf16 v[152:155], a[204:207], v[92:95], v[152:155]
    v_fma_f32 v246, v132, s21, -v218
    s_waitcnt lgkmcnt(2)
    v_mfma_f32_16x16x32_bf16 v[136:139], a[208:211], v[32:35], v[136:139]
    ds_read_b128 a[220:223], v225 offset:49408
    v_mfma_f32_16x16x32_bf16 v[144:147], a[208:211], v[64:67], v[144:147]
    v_exp_f32 v246, v246
    v_mfma_f32_16x16x32_bf16 v[152:155], a[208:211], v[96:99], v[152:155]
    v_fma_f32 v247, v133, s21, -v218
    s_waitcnt lgkmcnt(2)
    v_mfma_f32_16x16x32_bf16 v[136:139], a[212:215], v[36:39], v[136:139]
    ds_read_b128 a[192:195], v222 offset:57344
    v_mfma_f32_16x16x32_bf16 v[144:147], a[212:215], v[68:71], v[144:147]
    v_exp_f32 v247, v247
    v_mfma_f32_16x16x32_bf16 v[152:155], a[212:215], v[100:103], v[152:155]
    v_fma_f32 v248, v134, s21, -v218
    s_waitcnt lgkmcnt(2)
    v_mfma_f32_16x16x32_bf16 v[136:139], a[216:219], v[40:43], v[136:139]
    ds_read_b128 a[196:199], v223 offset:57344
    v_mfma_f32_16x16x32_bf16 v[144:147], a[216:219], v[72:75], v[144:147]
    v_exp_f32 v248, v248
    v_mfma_f32_16x16x32_bf16 v[152:155], a[216:219], v[104:107], v[152:155]
    v_fma_f32 v249, v135, s21, -v218
    s_waitcnt lgkmcnt(2)
    v_mfma_f32_16x16x32_bf16 v[136:139], a[220:223], v[44:47], v[136:139]
    ds_read_b128 a[200:203], v224 offset:57344
    v_mfma_f32_16x16x32_bf16 v[144:147], a[220:223], v[76:79], v[144:147]
    v_exp_f32 v249, v249
    v_mfma_f32_16x16x32_bf16 v[152:155], a[220:223], v[108:111], v[152:155]
    v_cvt_pk_bf16_f32 v160, v184, v185
    v_cvt_pk_bf16_f32 v161, v186, v187
    s_waitcnt lgkmcnt(2)
    v_mfma_f32_16x16x32_bf16 v[140:143], a[192:195], v[16:19], 0
    ds_read_b128 a[204:207], v225 offset:57344
    v_cvt_pk_bf16_f32 v164, v188, v189
    v_mfma_f32_16x16x32_bf16 v[148:151], a[192:195], v[48:51], 0
    v_cvt_pk_bf16_f32 v165, v190, v191
    v_cvt_pk_bf16_f32 v162, v192, v193
    v_mfma_f32_16x16x32_bf16 v[156:159], a[192:195], v[80:83], 0
    v_cvt_pk_bf16_f32 v163, v194, v195
    v_cvt_pk_bf16_f32 v166, v196, v197
    s_waitcnt lgkmcnt(2)
    v_mfma_f32_16x16x32_bf16 v[140:143], a[196:199], v[20:23], v[140:143]
    ds_read_b128 a[208:211], v222 offset:57600
    v_cvt_pk_bf16_f32 v167, v198, v199
    v_mfma_f32_16x16x32_bf16 v[148:151], a[196:199], v[52:55], v[148:151]
    v_cvt_pk_bf16_f32 v168, v242, v243
    v_cvt_pk_bf16_f32 v169, v244, v245
    v_mfma_f32_16x16x32_bf16 v[156:159], a[196:199], v[84:87], v[156:159]
    v_cvt_pk_bf16_f32 v170, v246, v247
    v_cvt_pk_bf16_f32 v171, v248, v249
    s_waitcnt lgkmcnt(2)
    v_mfma_f32_16x16x32_bf16 v[140:143], a[200:203], v[24:27], v[140:143]
    ds_read_b128 a[212:215], v223 offset:57600
    v_mfma_f32_16x16x32_bf16 v[148:151], a[200:203], v[56:59], v[148:151]
    v_mfma_f32_16x16x32_bf16 v[156:159], a[200:203], v[88:91], v[156:159]
    s_waitcnt lgkmcnt(2)
    v_mfma_f32_16x16x32_bf16 v[140:143], a[204:207], v[28:31], v[140:143]
    ds_read_b128 a[216:219], v224 offset:57600
    v_mfma_f32_16x16x32_bf16 v[148:151], a[204:207], v[60:63], v[148:151]
    v_mfma_f32_16x16x32_bf16 v[156:159], a[204:207], v[92:95], v[156:159]
    v_mfma_f32_16x16x32_bf16 v[200:203], v[212:215], v[160:163], 0
    ds_read_b128 a[220:223], v225 offset:57600
    ds_read_b64_tr_b16 a[224:225], v226 offset:32768
    v_mfma_f32_16x16x32_bf16 v[204:207], v[212:215], v[164:167], 0
    ds_read_b64_tr_b16 a[226:227], v226 offset:40960
    ds_read_b64_tr_b16 a[228:229], v227 offset:32768
    v_mfma_f32_16x16x32_bf16 v[208:211], v[212:215], v[168:171], 0
    ds_read_b64_tr_b16 a[230:231], v227 offset:40960
    ds_read_b64_tr_b16 a[232:233], v228 offset:32768
    s_waitcnt lgkmcnt(8)
    v_mfma_f32_16x16x32_bf16 v[140:143], a[208:211], v[32:35], v[140:143]
    ds_read_b64_tr_b16 a[234:235], v228 offset:40960
    v_mfma_f32_16x16x32_bf16 v[148:151], a[208:211], v[64:67], v[148:151]
    v_mfma_f32_16x16x32_bf16 v[156:159], a[208:211], v[96:99], v[156:159]
    s_waitcnt lgkmcnt(8)
    v_mfma_f32_16x16x32_bf16 v[140:143], a[212:215], v[36:39], v[140:143]
    v_mfma_f32_16x16x32_bf16 v[148:151], a[212:215], v[68:71], v[148:151]
    v_mfma_f32_16x16x32_bf16 v[156:159], a[212:215], v[100:103], v[156:159]
    s_waitcnt lgkmcnt(7)
    v_mfma_f32_16x16x32_bf16 v[140:143], a[216:219], v[40:43], v[140:143]
    v_mfma_f32_16x16x32_bf16 v[148:151], a[216:219], v[72:75], v[148:151]
    v_mfma_f32_16x16x32_bf16 v[156:159], a[216:219], v[104:107], v[156:159]
    s_waitcnt lgkmcnt(6)
    v_mfma_f32_16x16x32_bf16 v[140:143], a[220:223], v[44:47], v[140:143]
    v_mfma_f32_16x16x32_bf16 v[148:151], a[220:223], v[76:79], v[148:151]
    v_mfma_f32_16x16x32_bf16 v[156:159], a[220:223], v[108:111], v[156:159]
    v_max3_f32 v250, v200, v204, v208
    v_cmp_nle_f32 vcc, v250, s22
    s_cbranch_vccz L_ok_6
    s_swappc_b64 s[44:45], s[40:41]
L_ok_6:
    v_add_f32 v219, v219, v200
    v_add_f32 v220, v220, v204
    v_add_f32 v221, v221, v208
    s_waitcnt vmcnt(0)
    s_barrier
    s_waitcnt lgkmcnt(4)
    v_mfma_f32_16x16x32_bf16 a[0:3], a[224:227], v[160:163], a[0:3]
    ds_read_b64_tr_b16 a[236:237], v229 offset:32768
    ds_read_b64_tr_b16 a[238:239], v229 offset:40960
    v_mfma_f32_16x16x32_bf16 a[64:67], a[224:227], v[164:167], a[64:67]
    v_fma_f32 v184, v136, s21, -v216
    v_mfma_f32_16x16x32_bf16 a[128:131], a[224:227], v[168:171], a[128:131]
    v_exp_f32 v184, v184
    s_waitcnt lgkmcnt(4)
    v_mfma_f32_16x16x32_bf16 a[4:7], a[228:231], v[160:163], a[4:7]
    ds_read_b64_tr_b16 a[240:241], v230 offset:32768
    ds_read_b64_tr_b16 a[242:243], v230 offset:40960
    v_mfma_f32_16x16x32_bf16 a[68:71], a[228:231], v[164:167], a[68:71]
    v_fma_f32 v185, v137, s21, -v216
    v_mfma_f32_16x16x32_bf16 a[132:135], a[228:231], v[168:171], a[132:135]
    v_exp_f32 v185, v185
    s_waitcnt lgkmcnt(4)
    v_mfma_f32_16x16x32_bf16 a[8:11], a[232:235], v[160:163], a[8:11]
    ds_read_b64_tr_b16 a[244:245], v231 offset:32768
    ds_read_b64_tr_b16 a[246:247], v231 offset:40960
    v_mfma_f32_16x16x32_bf16 a[72:75], a[232:235], v[164:167], a[72:75]
    v_fma_f32 v186, v138, s21, -v216
    v_mfma_f32_16x16x32_bf16 a[136:139], a[232:235], v[168:171], a[136:139]
    v_exp_f32 v186, v186
    s_waitcnt lgkmcnt(4)
    v_mfma_f32_16x16x32_bf16 a[12:15], a[236:239], v[160:163], a[12:15]
    ds_read_b64_tr_b16 a[248:249], v232 offset:32768
    ds_read_b64_tr_b16 a[250:251], v232 offset:40960
    v_mfma_f32_16x16x32_bf16 a[76:79], a[236:239], v[164:167], a[76:79]
    v_fma_f32 v187, v139, s21, -v216
    v_mfma_f32_16x16x32_bf16 a[140:143], a[236:239], v[168:171], a[140:143]
    v_exp_f32 v187, v187
    s_waitcnt lgkmcnt(4)
    v_mfma_f32_16x16x32_bf16 a[16:19], a[240:243], v[160:163], a[16:19]
    ds_read_b64_tr_b16 a[252:253], v233 offset:32768
    ds_read_b64_tr_b16 a[254:255], v233 offset:40960
    v_mfma_f32_16x16x32_bf16 a[80:83], a[240:243], v[164:167], a[80:83]
    v_fma_f32 v188, v144, s21, -v217
    v_mfma_f32_16x16x32_bf16 a[144:147], a[240:243], v[168:171], a[144:147]
    v_exp_f32 v188, v188
    s_waitcnt lgkmcnt(4)
    v_mfma_f32_16x16x32_bf16 a[20:23], a[244:247], v[160:163], a[20:23]
    ds_read_b64_tr_b16 a[224:225], v226 offset:33024
    ds_read_b64_tr_b16 a[226:227], v226 offset:41216
    v_mfma_f32_16x16x32_bf16 a[84:87], a[244:247], v[164:167], a[84:87]
    v_fma_f32 v189, v145, s21, -v217
    v_mfma_f32_16x16x32_bf16 a[148:151], a[244:247], v[168:171], a[148:151]
    v_exp_f32 v189, v189
    s_waitcnt lgkmcnt(4)
    v_mfma_f32_16x16x32_bf16 a[24:27], a[248:251], v[160:163], a[24:27]
    ds_read_b64_tr_b16 a[228:229], v227 offset:33024
    ds_read_b64_tr_b16 a[230:231], v227 offset:41216
    v_mfma_f32_16x16x32_bf16 a[88:91], a[248:251], v[164:167], a[88:91]
    v_fma_f32 v190, v146, s21, -v217
    v_mfma_f32_16x16x32_bf16 a[152:155], a[248:251], v[168:171], a[152:155]
    v_exp_f32 v190, v190
    s_waitcnt lgkmcnt(4)
    v_mfma_f32_16x16x32_bf16 a[28:31], a[252:255], v[160:163], a[28:31]
    ds_read_b64_tr_b16 a[232:233], v228 offset:33024
    ds_read_b64_tr_b16 a[234:235], v228 offset:41216
    v_mfma_f32_16x16x32_bf16 a[92:95], a[252:255], v[164:167], a[92:95]
    v_fma_f32 v191, v147, s21, -v217
    v_mfma_f32_16x16x32_bf16 a[156:159], a[252:255], v[168:171], a[156:159]
    v_exp_f32 v191, v191
    s_waitcnt lgkmcnt(4)
    v_mfma_f32_16x16x32_bf16 a[32:35], a[224:227], v[160:163], a[32:35]
    ds_read_b64_tr_b16 a[236:237], v229 offset:33024
    ds_read_b64_tr_b16 a[238:239], v229 offset:41216
    v_mfma_f32_16x16x32_bf16 a[96:99], a[224:227], v[164:167], a[96:99]
    v_fma_f32 v192, v140, s21, -v216
    v_mfma_f32_16x16x32_bf16 a[160:163], a[224:227], v[168:171], a[160:163]
    v_exp_f32 v192, v192
    s_waitcnt lgkmcnt(4)
    v_mfma_f32_16x16x32_bf16 a[36:39], a[228:231], v[160:163], a[36:39]
    ds_read_b64_tr_b16 a[240:241], v230 offset:33024
    ds_read_b64_tr_b16 a[242:243], v230 offset:41216
    v_mfma_f32_16x16x32_bf16 a[100:103], a[228:231], v[164:167], a[100:103]
    v_fma_f32 v193, v141, s21, -v216
    v_mfma_f32_16x16x32_bf16 a[164:167], a[228:231], v[168:171], a[164:167]
    v_exp_f32 v193, v193
    s_waitcnt lgkmcnt(4)
    v_mfma_f32_16x16x32_bf16 a[40:43], a[232:235], v[160:163], a[40:43]
    ds_read_b64_tr_b16 a[244:245], v231 offset:33024
    ds_read_b64_tr_b16 a[246:247], v231 offset:41216
    v_mfma_f32_16x16x32_bf16 a[104:107], a[232:235], v[164:167], a[104:107]
    v_fma_f32 v194, v142, s21, -v216
    v_mfma_f32_16x16x32_bf16 a[168:171], a[232:235], v[168:171], a[168:171]
    v_exp_f32 v194, v194
    s_waitcnt lgkmcnt(4)
    v_mfma_f32_16x16x32_bf16 a[44:47], a[236:239], v[160:163], a[44:47]
    ds_read_b64_tr_b16 a[248:249], v232 offset:33024
    ds_read_b64_tr_b16 a[250:251], v232 offset:41216
    v_mfma_f32_16x16x32_bf16 a[108:111], a[236:239], v[164:167], a[108:111]
    v_fma_f32 v195, v143, s21, -v216
    v_mfma_f32_16x16x32_bf16 a[172:175], a[236:239], v[168:171], a[172:175]
    v_exp_f32 v195, v195
    s_waitcnt lgkmcnt(4)
    v_mfma_f32_16x16x32_bf16 a[48:51], a[240:243], v[160:163], a[48:51]
    ds_read_b64_tr_b16 a[252:253], v233 offset:33024
    ds_read_b64_tr_b16 a[254:255], v233 offset:41216
    v_mfma_f32_16x16x32_bf16 a[112:115], a[240:243], v[164:167], a[112:115]
    v_fma_f32 v196, v148, s21, -v217
    ds_read_b128 a[192:195], v222 offset:0
    v_mfma_f32_16x16x32_bf16 a[176:179], a[240:243], v[168:171], a[176:179]
    v_exp_f32 v196, v196
    s_waitcnt lgkmcnt(5)
    v_mfma_f32_16x16x32_bf16 a[52:55], a[244:247], v[160:163], a[52:55]
    v_fma_f32 v197, v149, s21, -v217
    ds_read_b128 a[196:199], v223 offset:0
    v_mfma_f32_16x16x32_bf16 a[116:119], a[244:247], v[164:167], a[116:119]
    v_exp_f32 v197, v197
    v_mfma_f32_16x16x32_bf16 a[180:183], a[244:247], v[168:171], a[180:183]
    v_fma_f32 v198, v150, s21, -v217
    ds_read_b128 a[200:203], v224 offset:0
    s_waitcnt lgkmcnt(5)
    v_mfma_f32_16x16x32_bf16 a[56:59], a[248:251], v[160:163], a[56:59]
    v_exp_f32 v198, v198
    v_mfma_f32_16x16x32_bf16 a[120:123], a[248:251], v[164:167], a[120:123]
    v_fma_f32 v199, v151, s21, -v217
    v_mfma_f32_16x16x32_bf16 a[184:187], a[248:251], v[168:171], a[184:187]
    v_exp_f32 v199, v199
    s_waitcnt lgkmcnt(3)
    v_mfma_f32_16x16x32_bf16 a[60:63], a[252:255], v[160:163], a[60:63]
    v_mfma_f32_16x16x32_bf16 a[124:127], a[252:255], v[164:167], a[124:127]
    v_mfma_f32_16x16x32_bf16 a[188:191], a[252:255], v[168:171], a[188:191]
    v_fma_f32 v242, v152, s21, -v218
    v_exp_f32 v242, v242
    v_fma_f32 v243, v153, s21, -v218
    v_exp_f32 v243, v243
    v_fma_f32 v244, v154, s21, -v218
    v_exp_f32 v244, v244
    v_fma_f32 v245, v155, s21, -v218
    v_exp_f32 v245, v245
    v_fma_f32 v246, v156, s21, -v218
    v_exp_f32 v246, v246
    v_fma_f32 v247, v157, s21, -v218
    v_exp_f32 v247, v247
    v_fma_f32 v248, v158, s21, -v218
    v_exp_f32 v248, v248
    v_fma_f32 v249, v159, s21, -v218
    v_exp_f32 v249, v249
    v_cvt_pk_bf16_f32 v172, v184, v185
    v_cvt_pk_bf16_f32 v173, v186, v187
    v_cvt_pk_bf16_f32 v176, v188, v189
    v_cvt_pk_bf16_f32 v177, v190, v191
    v_cvt_pk_bf16_f32 v174, v192, v193
    v_cvt_pk_bf16_f32 v175, v194, v195
    v_cvt_pk_bf16_f32 v178, v196, v197
    v_cvt_pk_bf16_f32 v179, v198, v199
    v_cvt_pk_bf16_f32 v180, v242, v243
    v_cvt_pk_bf16_f32 v181, v244, v245
    v_cvt_pk_bf16_f32 v182, v246, v247
    v_cvt_pk_bf16_f32 v183, v248, v249
    v_mfma_f32_16x16x32_bf16 v[200:203], v[212:215], v[172:175], 0
    v_mfma_f32_16x16x32_bf16 v[204:207], v[212:215], v[176:179], 0
    v_mfma_f32_16x16x32_bf16 v[208:211], v[212:215], v[180:183], 0
    ds_read_b64_tr_b16 a[224:225], v226 offset:49152
    ds_read_b64_tr_b16 a[226:227], v226 offset:57344
    ds_read_b64_tr_b16 a[228:229], v227 offset:49152
    ds_read_b64_tr_b16 a[230:231], v227 offset:57344
    ds_read_b64_tr_b16 a[232:233], v228 offset:49152
    ds_read_b64_tr_b16 a[234:235], v228 offset:57344
    s_nop 1
    v_max3_f32 v250, v200, v204, v208
    v_cmp_nle_f32 vcc, v250, s22
    s_cbranch_vccz L_ok_7
    s_swappc_b64 s[44:45], s[42:43]
L_ok_7:
    v_add_f32 v219, v219, v200
    v_add_f32 v220, v220, v204
    v_add_f32 v221, v221, v208
    s_waitcnt vmcnt(0)
    s_barrier
    s_waitcnt lgkmcnt(4)
    v_mfma_f32_16x16x32_bf16 a[0:3], a[224:227], v[172:175], a[0:3]
    ds_read_b64_tr_b16 a[236:237], v229 offset:49152
    ds_read_b64_tr_b16 a[238:239], v229 offset:57344
    v_mfma_f32_16x16x32_bf16 a[64:67], a[224:227], v[176:179], a[64:67]
    v_mfma_f32_16x16x32_bf16 a[128:131], a[224:227], v[180:183], a[128:131]
    s_waitcnt lgkmcnt(4)
    v_mfma_f32_16x16x32_bf16 a[4:7], a[228:231], v[172:175], a[4:7]
    ds_read_b64_tr_b16 a[240:241], v230 offset:49152
    ds_read_b64_tr_b16 a[242:243], v230 offset:57344
    v_mfma_f32_16x16x32_bf16 a[68:71], a[228:231], v[176:179], a[68:71]
    v_mfma_f32_16x16x32_bf16 a[132:135], a[228:231], v[180:183], a[132:135]
    s_waitcnt lgkmcnt(4)
    v_mfma_f32_16x16x32_bf16 a[8:11], a[232:235], v[172:175], a[8:11]
    ds_read_b64_tr_b16 a[244:245], v231 offset:49152
    ds_read_b64_tr_b16 a[246:247], v231 offset:57344
    v_mfma_f32_16x16x32_bf16 a[72:75], a[232:235], v[176:179], a[72:75]
    v_mfma_f32_16x16x32_bf16 a[136:139], a[232:235], v[180:183], a[136:139]
    s_waitcnt lgkmcnt(4)
    v_mfma_f32_16x16x32_bf16 a[12:15], a[236:239], v[172:175], a[12:15]
    ds_read_b64_tr_b16 a[248:249], v232 offset:49152
    ds_read_b64_tr_b16 a[250:251], v232 offset:57344
    v_mfma_f32_16x16x32_bf16 a[76:79], a[236:239], v[176:179], a[76:79]
    v_mfma_f32_16x16x32_bf16 a[140:143], a[236:239], v[180:183], a[140:143]
    s_waitcnt lgkmcnt(4)
    v_mfma_f32_16x16x32_bf16 a[16:19], a[240:243], v[172:175], a[16:19]
    ds_read_b64_tr_b16 a[252:253], v233 offset:49152
    ds_read_b64_tr_b16 a[254:255], v233 offset:57344
    v_mfma_f32_16x16x32_bf16 a[80:83], a[240:243], v[176:179], a[80:83]
    v_mfma_f32_16x16x32_bf16 a[144:147], a[240:243], v[180:183], a[144:147]
    s_waitcnt lgkmcnt(4)
    v_mfma_f32_16x16x32_bf16 a[20:23], a[244:247], v[172:175], a[20:23]
    ds_read_b64_tr_b16 a[224:225], v226 offset:49408
    ds_read_b64_tr_b16 a[226:227], v226 offset:57600
    v_mfma_f32_16x16x32_bf16 a[84:87], a[244:247], v[176:179], a[84:87]
    v_mfma_f32_16x16x32_bf16 a[148:151], a[244:247], v[180:183], a[148:151]
    s_waitcnt lgkmcnt(4)
    v_mfma_f32_16x16x32_bf16 a[24:27], a[248:251], v[172:175], a[24:27]
    ds_read_b64_tr_b16 a[228:229], v227 offset:49408
    ds_read_b64_tr_b16 a[230:231], v227 offset:57600
    v_mfma_f32_16x16x32_bf16 a[88:91], a[248:251], v[176:179], a[88:91]
    v_mfma_f32_16x16x32_bf16 a[152:155], a[248:251], v[180:183], a[152:155]
    s_waitcnt lgkmcnt(4)
    v_mfma_f32_16x16x32_bf16 a[28:31], a[252:255], v[172:175], a[28:31]
    ds_read_b64_tr_b16 a[232:233], v228 offset:49408
    ds_read_b64_tr_b16 a[234:235], v228 offset:57600
    v_mfma_f32_16x16x32_bf16 a[92:95], a[252:255], v[176:179], a[92:95]
    v_mfma_f32_16x16x32_bf16 a[156:159], a[252:255], v[180:183], a[156:159]
    s_waitcnt lgkmcnt(4)
    v_mfma_f32_16x16x32_bf16 a[32:35], a[224:227], v[172:175], a[32:35]
    ds_read_b64_tr_b16 a[236:237], v229 offset:49408
    ds_read_b64_tr_b16 a[238:239], v229 offset:57600
    v_mfma_f32_16x16x32_bf16 a[96:99], a[224:227], v[176:179], a[96:99]
    v_mfma_f32_16x16x32_bf16 a[160:163], a[224:227], v[180:183], a[160:163]
    s_waitcnt lgkmcnt(4)
    v_mfma_f32_16x16x32_bf16 a[36:39], a[228:231], v[172:175], a[36:39]
    ds_read_b64_tr_b16 a[240:241], v230 offset:49408
    ds_read_b64_tr_b16 a[242:243], v230 offset:57600
    v_mfma_f32_16x16x32_bf16 a[100:103], a[228:231], v[176:179], a[100:103]
    v_mfma_f32_16x16x32_bf16 a[164:167], a[228:231], v[180:183], a[164:167]
    s_waitcnt lgkmcnt(4)
    v_mfma_f32_16x16x32_bf16 a[40:43], a[232:235], v[172:175], a[40:43]
    ds_read_b64_tr_b16 a[244:245], v231 offset:49408
    ds_read_b64_tr_b16 a[246:247], v231 offset:57600
    v_mfma_f32_16x16x32_bf16 a[104:107], a[232:235], v[176:179], a[104:107]
    v_mfma_f32_16x16x32_bf16 a[168:171], a[232:235], v[180:183], a[168:171]
    s_waitcnt lgkmcnt(4)
    v_mfma_f32_16x16x32_bf16 a[44:47], a[236:239], v[172:175], a[44:47]
    ds_read_b64_tr_b16 a[248:249], v232 offset:49408
    ds_read_b64_tr_b16 a[250:251], v232 offset:57600
    v_mfma_f32_16x16x32_bf16 a[108:111], a[236:239], v[176:179], a[108:111]
    v_mfma_f32_16x16x32_bf16 a[172:175], a[236:239], v[180:183], a[172:175]
    s_waitcnt lgkmcnt(4)
    v_mfma_f32_16x16x32_bf16 a[48:51], a[240:243], v[172:175], a[48:51]
    ds_read_b64_tr_b16 a[252:253], v233 offset:49408
    ds_read_b64_tr_b16 a[254:255], v233 offset:57600
    v_mfma_f32_16x16x32_bf16 a[112:115], a[240:243], v[176:179], a[112:115]
    v_mfma_f32_16x16x32_bf16 a[176:179], a[240:243], v[180:183], a[176:179]
    s_waitcnt lgkmcnt(4)
    v_mfma_f32_16x16x32_bf16 a[52:55], a[244:247], v[172:175], a[52:55]
    v_mfma_f32_16x16x32_bf16 a[116:119], a[244:247], v[176:179], a[116:119]
    v_mfma_f32_16x16x32_bf16 a[180:183], a[244:247], v[180:183], a[180:183]
    s_waitcnt lgkmcnt(2)
    v_mfma_f32_16x16x32_bf16 a[56:59], a[248:251], v[172:175], a[56:59]
    v_mfma_f32_16x16x32_bf16 a[120:123], a[248:251], v[176:179], a[120:123]
    v_mfma_f32_16x16x32_bf16 a[184:187], a[248:251], v[180:183], a[184:187]
    s_waitcnt lgkmcnt(0)
    v_mfma_f32_16x16x32_bf16 a[60:63], a[252:255], v[172:175], a[60:63]
    v_mfma_f32_16x16x32_bf16 a[124:127], a[252:255], v[176:179], a[124:127]
    v_mfma_f32_16x16x32_bf16 a[188:191], a[252:255], v[180:183], a[188:191]
    v_rcp_f32 v250, v219
    v_rcp_f32 v251, v220
    v_rcp_f32 v252, v221
    s_barrier
    v_and_b32 v2, 15, v1
    v_lshrrev_b32 v3, 4, v1
    v_lshrrev_b32 v4, 5, v1
    v_and_b32 v7, 31, v1
    s_mul_i32 s39, s20, 24576
    v_lshrrev_b32 v8, 1, v3
    v_and_b32 v9, 1, v3
    v_lshlrev_b32 v9, 3, v9
    v_lshl_add_u32 v9, v2, 9, v9
    v_add_u32 v9, s39, v9
    v_add_u32 v10, 0, v8
    v_xor_b32 v10, v10, v2
    v_lshl_add_u32 v226, v10, 4, v9
    v_add_u32 v10, 2, v8
    v_xor_b32 v10, v10, v2
    v_lshl_add_u32 v227, v10, 4, v9
    v_add_u32 v10, 4, v8
    v_xor_b32 v10, v10, v2
    v_lshl_add_u32 v228, v10, 4, v9
    v_add_u32 v10, 6, v8
    v_xor_b32 v10, v10, v2
    v_lshl_add_u32 v229, v10, 4, v9
    v_add_u32 v10, 8, v8
    v_xor_b32 v10, v10, v2
    v_lshl_add_u32 v230, v10, 4, v9
    v_add_u32 v10, 10, v8
    v_xor_b32 v10, v10, v2
    v_lshl_add_u32 v231, v10, 4, v9
    v_add_u32 v10, 12, v8
    v_xor_b32 v10, v10, v2
    v_lshl_add_u32 v232, v10, 4, v9
    v_add_u32 v10, 14, v8
    v_xor_b32 v10, v10, v2
    v_lshl_add_u32 v233, v10, 4, v9
    v_add_u32 v10, 0, v4
    v_xor_b32 v10, v10, v7
    v_lshlrev_b32 v10, 4, v10
    v_lshl_add_u32 v10, v4, 9, v10
    v_add_u32 v10, 0, v10
    v_add_u32 v64, s39, v10
    v_add_u32 v10, 2, v4
    v_xor_b32 v10, v10, v7
    v_lshlrev_b32 v10, 4, v10
    v_lshl_add_u32 v10, v4, 9, v10
    v_add_u32 v10, 1024, v10
    v_add_u32 v65, s39, v10
    v_add_u32 v10, 4, v4
    v_xor_b32 v10, v10, v7
    v_lshlrev_b32 v10, 4, v10
    v_lshl_add_u32 v10, v4, 9, v10
    v_add_u32 v10, 2048, v10
    v_add_u32 v66, s39, v10
    v_add_u32 v10, 6, v4
    v_xor_b32 v10, v10, v7
    v_lshlrev_b32 v10, 4, v10
    v_lshl_add_u32 v10, v4, 9, v10
    v_add_u32 v10, 3072, v10
    v_add_u32 v67, s39, v10
    v_add_u32 v10, 8, v4
    v_xor_b32 v10, v10, v7
    v_lshlrev_b32 v10, 4, v10
    v_lshl_add_u32 v10, v4, 9, v10
    v_add_u32 v10, 4096, v10
    v_add_u32 v68, s39, v10
    v_add_u32 v10, 10, v4
    v_xor_b32 v10, v10, v7
    v_lshlrev_b32 v10, 4, v10
    v_lshl_add_u32 v10, v4, 9, v10
    v_add_u32 v10, 5120, v10
    v_add_u32 v69, s39, v10
    v_add_u32 v10, 12, v4
    v_xor_b32 v10, v10, v7
    v_lshlrev_b32 v10, 4, v10
    v_lshl_add_u32 v10, v4, 9, v10
    v_add_u32 v10, 6144, v10
    v_add_u32 v70, s39, v10
    v_add_u32 v10, 14, v4
    v_xor_b32 v10, v10, v7
    v_lshlrev_b32 v10, 4, v10
    v_lshl_add_u32 v10, v4, 9, v10
    v_add_u32 v10, 7168, v10
    v_add_u32 v71, s39, v10
    v_lshlrev_b32 v11, 4, v7
    v_lshl_add_u32 v11, v4, 9, v11
    v_accvgpr_read_b32 v16, a0
    v_accvgpr_read_b32 v17, a1
    v_accvgpr_read_b32 v18, a2
    v_accvgpr_read_b32 v19, a3
    v_mul_f32 v16, v16, v250
    v_mul_f32 v17, v17, v250
    v_mul_f32 v18, v18, v250
    v_mul_f32 v19, v19, v250
    v_cvt_pk_bf16_f32 v20, v16, v17
    v_cvt_pk_bf16_f32 v21, v18, v19
    ds_write_b64 v226, v[20:21] offset:0
    v_accvgpr_read_b32 v22, a4
    v_accvgpr_read_b32 v23, a5
    v_accvgpr_read_b32 v24, a6
    v_accvgpr_read_b32 v25, a7
    v_mul_f32 v22, v22, v250
    v_mul_f32 v23, v23, v250
    v_mul_f32 v24, v24, v250
    v_mul_f32 v25, v25, v250
    v_cvt_pk_bf16_f32 v26, v22, v23
    v_cvt_pk_bf16_f32 v27, v24, v25
    ds_write_b64 v227, v[26:27] offset:0
    v_accvgpr_read_b32 v28, a8
    v_accvgpr_read_b32 v29, a9
    v_accvgpr_read_b32 v30, a10
    v_accvgpr_read_b32 v31, a11
    v_mul_f32 v28, v28, v250
    v_mul_f32 v29, v29, v250
    v_mul_f32 v30, v30, v250
    v_mul_f32 v31, v31, v250
    v_cvt_pk_bf16_f32 v32, v28, v29
    v_cvt_pk_bf16_f32 v33, v30, v31
    ds_write_b64 v228, v[32:33] offset:0
    v_accvgpr_read_b32 v34, a12
    v_accvgpr_read_b32 v35, a13
    v_accvgpr_read_b32 v36, a14
    v_accvgpr_read_b32 v37, a15
    v_mul_f32 v34, v34, v250
    v_mul_f32 v35, v35, v250
    v_mul_f32 v36, v36, v250
    v_mul_f32 v37, v37, v250
    v_cvt_pk_bf16_f32 v38, v34, v35
    v_cvt_pk_bf16_f32 v39, v36, v37
    ds_write_b64 v229, v[38:39] offset:0
    v_accvgpr_read_b32 v40, a16
    v_accvgpr_read_b32 v41, a17
    v_accvgpr_read_b32 v42, a18
    v_accvgpr_read_b32 v43, a19
    v_mul_f32 v40, v40, v250
    v_mul_f32 v41, v41, v250
    v_mul_f32 v42, v42, v250
    v_mul_f32 v43, v43, v250
    v_cvt_pk_bf16_f32 v44, v40, v41
    v_cvt_pk_bf16_f32 v45, v42, v43
    ds_write_b64 v230, v[44:45] offset:0
    v_accvgpr_read_b32 v46, a20
    v_accvgpr_read_b32 v47, a21
    v_accvgpr_read_b32 v48, a22
    v_accvgpr_read_b32 v49, a23
    v_mul_f32 v46, v46, v250
    v_mul_f32 v47, v47, v250
    v_mul_f32 v48, v48, v250
    v_mul_f32 v49, v49, v250
    v_cvt_pk_bf16_f32 v50, v46, v47
    v_cvt_pk_bf16_f32 v51, v48, v49
    ds_write_b64 v231, v[50:51] offset:0
    v_accvgpr_read_b32 v52, a24
    v_accvgpr_read_b32 v53, a25
    v_accvgpr_read_b32 v54, a26
    v_accvgpr_read_b32 v55, a27
    v_mul_f32 v52, v52, v250
    v_mul_f32 v53, v53, v250
    v_mul_f32 v54, v54, v250
    v_mul_f32 v55, v55, v250
    v_cvt_pk_bf16_f32 v56, v52, v53
    v_cvt_pk_bf16_f32 v57, v54, v55
    ds_write_b64 v232, v[56:57] offset:0
    v_accvgpr_read_b32 v58, a28
    v_accvgpr_read_b32 v59, a29
    v_accvgpr_read_b32 v60, a30
    v_accvgpr_read_b32 v61, a31
    v_mul_f32 v58, v58, v250
    v_mul_f32 v59, v59, v250
    v_mul_f32 v60, v60, v250
    v_mul_f32 v61, v61, v250
    v_cvt_pk_bf16_f32 v62, v58, v59
    v_cvt_pk_bf16_f32 v63, v60, v61
    ds_write_b64 v233, v[62:63] offset:0
    v_accvgpr_read_b32 v16, a32
    v_accvgpr_read_b32 v17, a33
    v_accvgpr_read_b32 v18, a34
    v_accvgpr_read_b32 v19, a35
    v_mul_f32 v16, v16, v250
    v_mul_f32 v17, v17, v250
    v_mul_f32 v18, v18, v250
    v_mul_f32 v19, v19, v250
    v_cvt_pk_bf16_f32 v20, v16, v17
    v_cvt_pk_bf16_f32 v21, v18, v19
    ds_write_b64 v226, v[20:21] offset:256
    v_accvgpr_read_b32 v22, a36
    v_accvgpr_read_b32 v23, a37
    v_accvgpr_read_b32 v24, a38
    v_accvgpr_read_b32 v25, a39
    v_mul_f32 v22, v22, v250
    v_mul_f32 v23, v23, v250
    v_mul_f32 v24, v24, v250
    v_mul_f32 v25, v25, v250
    v_cvt_pk_bf16_f32 v26, v22, v23
    v_cvt_pk_bf16_f32 v27, v24, v25
    ds_write_b64 v227, v[26:27] offset:256
    v_accvgpr_read_b32 v28, a40
    v_accvgpr_read_b32 v29, a41
    v_accvgpr_read_b32 v30, a42
    v_accvgpr_read_b32 v31, a43
    v_mul_f32 v28, v28, v250
    v_mul_f32 v29, v29, v250
    v_mul_f32 v30, v30, v250
    v_mul_f32 v31, v31, v250
    v_cvt_pk_bf16_f32 v32, v28, v29
    v_cvt_pk_bf16_f32 v33, v30, v31
    ds_write_b64 v228, v[32:33] offset:256
    v_accvgpr_read_b32 v34, a44
    v_accvgpr_read_b32 v35, a45
    v_accvgpr_read_b32 v36, a46
    v_accvgpr_read_b32 v37, a47
    v_mul_f32 v34, v34, v250
    v_mul_f32 v35, v35, v250
    v_mul_f32 v36, v36, v250
    v_mul_f32 v37, v37, v250
    v_cvt_pk_bf16_f32 v38, v34, v35
    v_cvt_pk_bf16_f32 v39, v36, v37
    ds_write_b64 v229, v[38:39] offset:256
    v_accvgpr_read_b32 v40, a48
    v_accvgpr_read_b32 v41, a49
    v_accvgpr_read_b32 v42, a50
    v_accvgpr_read_b32 v43, a51
    v_mul_f32 v40, v40, v250
    v_mul_f32 v41, v41, v250
    v_mul_f32 v42, v42, v250
    v_mul_f32 v43, v43, v250
    v_cvt_pk_bf16_f32 v44, v40, v41
    v_cvt_pk_bf16_f32 v45, v42, v43
    ds_write_b64 v230, v[44:45] offset:256
    v_accvgpr_read_b32 v46, a52
    v_accvgpr_read_b32 v47, a53
    v_accvgpr_read_b32 v48, a54
    v_accvgpr_read_b32 v49, a55
    v_mul_f32 v46, v46, v250
    v_mul_f32 v47, v47, v250
    v_mul_f32 v48, v48, v250
    v_mul_f32 v49, v49, v250
    v_cvt_pk_bf16_f32 v50, v46, v47
    v_cvt_pk_bf16_f32 v51, v48, v49
    ds_write_b64 v231, v[50:51] offset:256
    v_accvgpr_read_b32 v52, a56
    v_accvgpr_read_b32 v53, a57
    v_accvgpr_read_b32 v54, a58
    v_accvgpr_read_b32 v55, a59
    v_mul_f32 v52, v52, v250
    v_mul_f32 v53, v53, v250
    v_mul_f32 v54, v54, v250
    v_mul_f32 v55, v55, v250
    v_cvt_pk_bf16_f32 v56, v52, v53
    v_cvt_pk_bf16_f32 v57, v54, v55
    ds_write_b64 v232, v[56:57] offset:256
    v_accvgpr_read_b32 v58, a60
    v_accvgpr_read_b32 v59, a61
    v_accvgpr_read_b32 v60, a62
    v_accvgpr_read_b32 v61, a63
    v_mul_f32 v58, v58, v250
    v_mul_f32 v59, v59, v250
    v_mul_f32 v60, v60, v250
    v_mul_f32 v61, v61, v250
    v_cvt_pk_bf16_f32 v62, v58, v59
    v_cvt_pk_bf16_f32 v63, v60, v61
    ds_write_b64 v233, v[62:63] offset:256
    v_accvgpr_read_b32 v16, a64
    v_accvgpr_read_b32 v17, a65
    v_accvgpr_read_b32 v18, a66
    v_accvgpr_read_b32 v19, a67
    v_mul_f32 v16, v16, v251
    v_mul_f32 v17, v17, v251
    v_mul_f32 v18, v18, v251
    v_mul_f32 v19, v19, v251
    v_cvt_pk_bf16_f32 v20, v16, v17
    v_cvt_pk_bf16_f32 v21, v18, v19
    ds_write_b64 v226, v[20:21] offset:8192
    v_accvgpr_read_b32 v22, a68
    v_accvgpr_read_b32 v23, a69
    v_accvgpr_read_b32 v24, a70
    v_accvgpr_read_b32 v25, a71
    v_mul_f32 v22, v22, v251
    v_mul_f32 v23, v23, v251
    v_mul_f32 v24, v24, v251
    v_mul_f32 v25, v25, v251
    v_cvt_pk_bf16_f32 v26, v22, v23
    v_cvt_pk_bf16_f32 v27, v24, v25
    ds_write_b64 v227, v[26:27] offset:8192
    v_accvgpr_read_b32 v28, a72
    v_accvgpr_read_b32 v29, a73
    v_accvgpr_read_b32 v30, a74
    v_accvgpr_read_b32 v31, a75
    v_mul_f32 v28, v28, v251
    v_mul_f32 v29, v29, v251
    v_mul_f32 v30, v30, v251
    v_mul_f32 v31, v31, v251
    v_cvt_pk_bf16_f32 v32, v28, v29
    v_cvt_pk_bf16_f32 v33, v30, v31
    ds_write_b64 v228, v[32:33] offset:8192
    v_accvgpr_read_b32 v34, a76
    v_accvgpr_read_b32 v35, a77
    v_accvgpr_read_b32 v36, a78
    v_accvgpr_read_b32 v37, a79
    v_mul_f32 v34, v34, v251
    v_mul_f32 v35, v35, v251
    v_mul_f32 v36, v36, v251
    v_mul_f32 v37, v37, v251
    v_cvt_pk_bf16_f32 v38, v34, v35
    v_cvt_pk_bf16_f32 v39, v36, v37
    ds_write_b64 v229, v[38:39] offset:8192
    v_accvgpr_read_b32 v40, a80
    v_accvgpr_read_b32 v41, a81
    v_accvgpr_read_b32 v42, a82
    v_accvgpr_read_b32 v43, a83
    v_mul_f32 v40, v40, v251
    v_mul_f32 v41, v41, v251
    v_mul_f32 v42, v42, v251
    v_mul_f32 v43, v43, v251
    v_cvt_pk_bf16_f32 v44, v40, v41
    v_cvt_pk_bf16_f32 v45, v42, v43
    ds_write_b64 v230, v[44:45] offset:8192
    v_accvgpr_read_b32 v46, a84
    v_accvgpr_read_b32 v47, a85
    v_accvgpr_read_b32 v48, a86
    v_accvgpr_read_b32 v49, a87
    v_mul_f32 v46, v46, v251
    v_mul_f32 v47, v47, v251
    v_mul_f32 v48, v48, v251
    v_mul_f32 v49, v49, v251
    v_cvt_pk_bf16_f32 v50, v46, v47
    v_cvt_pk_bf16_f32 v51, v48, v49
    ds_write_b64 v231, v[50:51] offset:8192
    v_accvgpr_read_b32 v52, a88
    v_accvgpr_read_b32 v53, a89
    v_accvgpr_read_b32 v54, a90
    v_accvgpr_read_b32 v55, a91
    v_mul_f32 v52, v52, v251
    v_mul_f32 v53, v53, v251
    v_mul_f32 v54, v54, v251
    v_mul_f32 v55, v55, v251
    v_cvt_pk_bf16_f32 v56, v52, v53
    v_cvt_pk_bf16_f32 v57, v54, v55
    ds_write_b64 v232, v[56:57] offset:8192
    v_accvgpr_read_b32 v58, a92
    v_accvgpr_read_b32 v59, a93
    v_accvgpr_read_b32 v60, a94
    v_accvgpr_read_b32 v61, a95
    v_mul_f32 v58, v58, v251
    v_mul_f32 v59, v59, v251
    v_mul_f32 v60, v60, v251
    v_mul_f32 v61, v61, v251
    v_cvt_pk_bf16_f32 v62, v58, v59
    v_cvt_pk_bf16_f32 v63, v60, v61
    ds_write_b64 v233, v[62:63] offset:8192
    v_accvgpr_read_b32 v16, a96
    v_accvgpr_read_b32 v17, a97
    v_accvgpr_read_b32 v18, a98
    v_accvgpr_read_b32 v19, a99
    v_mul_f32 v16, v16, v251
    v_mul_f32 v17, v17, v251
    v_mul_f32 v18, v18, v251
    v_mul_f32 v19, v19, v251
    v_cvt_pk_bf16_f32 v20, v16, v17
    v_cvt_pk_bf16_f32 v21, v18, v19
    ds_write_b64 v226, v[20:21] offset:8448
    v_accvgpr_read_b32 v22, a100
    v_accvgpr_read_b32 v23, a101
    v_accvgpr_read_b32 v24, a102
    v_accvgpr_read_b32 v25, a103
    v_mul_f32 v22, v22, v251
    v_mul_f32 v23, v23, v251
    v_mul_f32 v24, v24, v251
    v_mul_f32 v25, v25, v251
    v_cvt_pk_bf16_f32 v26, v22, v23
    v_cvt_pk_bf16_f32 v27, v24, v25
    ds_write_b64 v227, v[26:27] offset:8448
    v_accvgpr_read_b32 v28, a104
    v_accvgpr_read_b32 v29, a105
    v_accvgpr_read_b32 v30, a106
    v_accvgpr_read_b32 v31, a107
    v_mul_f32 v28, v28, v251
    v_mul_f32 v29, v29, v251
    v_mul_f32 v30, v30, v251
    v_mul_f32 v31, v31, v251
    v_cvt_pk_bf16_f32 v32, v28, v29
    v_cvt_pk_bf16_f32 v33, v30, v31
    ds_write_b64 v228, v[32:33] offset:8448
    v_accvgpr_read_b32 v34, a108
    v_accvgpr_read_b32 v35, a109
    v_accvgpr_read_b32 v36, a110
    v_accvgpr_read_b32 v37, a111
    v_mul_f32 v34, v34, v251
    v_mul_f32 v35, v35, v251
    v_mul_f32 v36, v36, v251
    v_mul_f32 v37, v37, v251
    v_cvt_pk_bf16_f32 v38, v34, v35
    v_cvt_pk_bf16_f32 v39, v36, v37
    ds_write_b64 v229, v[38:39] offset:8448
    v_accvgpr_read_b32 v40, a112
    v_accvgpr_read_b32 v41, a113
    v_accvgpr_read_b32 v42, a114
    v_accvgpr_read_b32 v43, a115
    v_mul_f32 v40, v40, v251
    v_mul_f32 v41, v41, v251
    v_mul_f32 v42, v42, v251
    v_mul_f32 v43, v43, v251
    v_cvt_pk_bf16_f32 v44, v40, v41
    v_cvt_pk_bf16_f32 v45, v42, v43
    ds_write_b64 v230, v[44:45] offset:8448
    v_accvgpr_read_b32 v46, a116
    v_accvgpr_read_b32 v47, a117
    v_accvgpr_read_b32 v48, a118
    v_accvgpr_read_b32 v49, a119
    v_mul_f32 v46, v46, v251
    v_mul_f32 v47, v47, v251
    v_mul_f32 v48, v48, v251
    v_mul_f32 v49, v49, v251
    v_cvt_pk_bf16_f32 v50, v46, v47
    v_cvt_pk_bf16_f32 v51, v48, v49
    ds_write_b64 v231, v[50:51] offset:8448
    v_accvgpr_read_b32 v52, a120
    v_accvgpr_read_b32 v53, a121
    v_accvgpr_read_b32 v54, a122
    v_accvgpr_read_b32 v55, a123
    v_mul_f32 v52, v52, v251
    v_mul_f32 v53, v53, v251
    v_mul_f32 v54, v54, v251
    v_mul_f32 v55, v55, v251
    v_cvt_pk_bf16_f32 v56, v52, v53
    v_cvt_pk_bf16_f32 v57, v54, v55
    ds_write_b64 v232, v[56:57] offset:8448
    v_accvgpr_read_b32 v58, a124
    v_accvgpr_read_b32 v59, a125
    v_accvgpr_read_b32 v60, a126
    v_accvgpr_read_b32 v61, a127
    v_mul_f32 v58, v58, v251
    v_mul_f32 v59, v59, v251
    v_mul_f32 v60, v60, v251
    v_mul_f32 v61, v61, v251
    v_cvt_pk_bf16_f32 v62, v58, v59
    v_cvt_pk_bf16_f32 v63, v60, v61
    ds_write_b64 v233, v[62:63] offset:8448
    v_accvgpr_read_b32 v16, a128
    v_accvgpr_read_b32 v17, a129
    v_accvgpr_read_b32 v18, a130
    v_accvgpr_read_b32 v19, a131
    v_mul_f32 v16, v16, v252
    v_mul_f32 v17, v17, v252
    v_mul_f32 v18, v18, v252
    v_mul_f32 v19, v19, v252
    v_cvt_pk_bf16_f32 v20, v16, v17
    v_cvt_pk_bf16_f32 v21, v18, v19
    ds_write_b64 v226, v[20:21] offset:16384
    v_accvgpr_read_b32 v22, a132
    v_accvgpr_read_b32 v23, a133
    v_accvgpr_read_b32 v24, a134
    v_accvgpr_read_b32 v25, a135
    v_mul_f32 v22, v22, v252
    v_mul_f32 v23, v23, v252
    v_mul_f32 v24, v24, v252
    v_mul_f32 v25, v25, v252
    v_cvt_pk_bf16_f32 v26, v22, v23
    v_cvt_pk_bf16_f32 v27, v24, v25
    ds_write_b64 v227, v[26:27] offset:16384
    v_accvgpr_read_b32 v28, a136
    v_accvgpr_read_b32 v29, a137
    v_accvgpr_read_b32 v30, a138
    v_accvgpr_read_b32 v31, a139
    v_mul_f32 v28, v28, v252
    v_mul_f32 v29, v29, v252
    v_mul_f32 v30, v30, v252
    v_mul_f32 v31, v31, v252
    v_cvt_pk_bf16_f32 v32, v28, v29
    v_cvt_pk_bf16_f32 v33, v30, v31
    ds_write_b64 v228, v[32:33] offset:16384
    v_accvgpr_read_b32 v34, a140
    v_accvgpr_read_b32 v35, a141
    v_accvgpr_read_b32 v36, a142
    v_accvgpr_read_b32 v37, a143
    v_mul_f32 v34, v34, v252
    v_mul_f32 v35, v35, v252
    v_mul_f32 v36, v36, v252
    v_mul_f32 v37, v37, v252
    v_cvt_pk_bf16_f32 v38, v34, v35
    v_cvt_pk_bf16_f32 v39, v36, v37
    ds_write_b64 v229, v[38:39] offset:16384
    v_accvgpr_read_b32 v40, a144
    v_accvgpr_read_b32 v41, a145
    v_accvgpr_read_b32 v42, a146
    v_accvgpr_read_b32 v43, a147
    v_mul_f32 v40, v40, v252
    v_mul_f32 v41, v41, v252
    v_mul_f32 v42, v42, v252
    v_mul_f32 v43, v43, v252
    v_cvt_pk_bf16_f32 v44, v40, v41
    v_cvt_pk_bf16_f32 v45, v42, v43
    ds_write_b64 v230, v[44:45] offset:16384
    v_accvgpr_read_b32 v46, a148
    v_accvgpr_read_b32 v47, a149
    v_accvgpr_read_b32 v48, a150
    v_accvgpr_read_b32 v49, a151
    v_mul_f32 v46, v46, v252
    v_mul_f32 v47, v47, v252
    v_mul_f32 v48, v48, v252
    v_mul_f32 v49, v49, v252
    v_cvt_pk_bf16_f32 v50, v46, v47
    v_cvt_pk_bf16_f32 v51, v48, v49
    ds_write_b64 v231, v[50:51] offset:16384
    v_accvgpr_read_b32 v52, a152
    v_accvgpr_read_b32 v53, a153
    v_accvgpr_read_b32 v54, a154
    v_accvgpr_read_b32 v55, a155
    v_mul_f32 v52, v52, v252
    v_mul_f32 v53, v53, v252
    v_mul_f32 v54, v54, v252
    v_mul_f32 v55, v55, v252
    v_cvt_pk_bf16_f32 v56, v52, v53
    v_cvt_pk_bf16_f32 v57, v54, v55
    ds_write_b64 v232, v[56:57] offset:16384
    v_accvgpr_read_b32 v58, a156
    v_accvgpr_read_b32 v59, a157
    v_accvgpr_read_b32 v60, a158
    v_accvgpr_read_b32 v61, a159
    v_mul_f32 v58, v58, v252
    v_mul_f32 v59, v59, v252
    v_mul_f32 v60, v60, v252
    v_mul_f32 v61, v61, v252
    v_cvt_pk_bf16_f32 v62, v58, v59
    v_cvt_pk_bf16_f32 v63, v60, v61
    ds_write_b64 v233, v[62:63] offset:16384
    v_accvgpr_read_b32 v16, a160
    v_accvgpr_read_b32 v17, a161
    v_accvgpr_read_b32 v18, a162
    v_accvgpr_read_b32 v19, a163
    v_mul_f32 v16, v16, v252
    v_mul_f32 v17, v17, v252
    v_mul_f32 v18, v18, v252
    v_mul_f32 v19, v19, v252
    v_cvt_pk_bf16_f32 v20, v16, v17
    v_cvt_pk_bf16_f32 v21, v18, v19
    ds_write_b64 v226, v[20:21] offset:16640
    v_accvgpr_read_b32 v22, a164
    v_accvgpr_read_b32 v23, a165
    v_accvgpr_read_b32 v24, a166
    v_accvgpr_read_b32 v25, a167
    v_mul_f32 v22, v22, v252
    v_mul_f32 v23, v23, v252
    v_mul_f32 v24, v24, v252
    v_mul_f32 v25, v25, v252
    v_cvt_pk_bf16_f32 v26, v22, v23
    v_cvt_pk_bf16_f32 v27, v24, v25
    ds_write_b64 v227, v[26:27] offset:16640
    v_accvgpr_read_b32 v28, a168
    v_accvgpr_read_b32 v29, a169
    v_accvgpr_read_b32 v30, a170
    v_accvgpr_read_b32 v31, a171
    v_mul_f32 v28, v28, v252
    v_mul_f32 v29, v29, v252
    v_mul_f32 v30, v30, v252
    v_mul_f32 v31, v31, v252
    v_cvt_pk_bf16_f32 v32, v28, v29
    v_cvt_pk_bf16_f32 v33, v30, v31
    ds_write_b64 v228, v[32:33] offset:16640
    v_accvgpr_read_b32 v34, a172
    v_accvgpr_read_b32 v35, a173
    v_accvgpr_read_b32 v36, a174
    v_accvgpr_read_b32 v37, a175
    v_mul_f32 v34, v34, v252
    v_mul_f32 v35, v35, v252
    v_mul_f32 v36, v36, v252
    v_mul_f32 v37, v37, v252
    v_cvt_pk_bf16_f32 v38, v34, v35
    v_cvt_pk_bf16_f32 v39, v36, v37
    ds_write_b64 v229, v[38:39] offset:16640
    v_accvgpr_read_b32 v40, a176
    v_accvgpr_read_b32 v41, a177
    v_accvgpr_read_b32 v42, a178
    v_accvgpr_read_b32 v43, a179
    v_mul_f32 v40, v40, v252
    v_mul_f32 v41, v41, v252
    v_mul_f32 v42, v42, v252
    v_mul_f32 v43, v43, v252
    v_cvt_pk_bf16_f32 v44, v40, v41
    v_cvt_pk_bf16_f32 v45, v42, v43
    ds_write_b64 v230, v[44:45] offset:16640
    v_accvgpr_read_b32 v46, a180
    v_accvgpr_read_b32 v47, a181
    v_accvgpr_read_b32 v48, a182
    v_accvgpr_read_b32 v49, a183
    v_mul_f32 v46, v46, v252
    v_mul_f32 v47, v47, v252
    v_mul_f32 v48, v48, v252
    v_mul_f32 v49, v49, v252
    v_cvt_pk_bf16_f32 v50, v46, v47
    v_cvt_pk_bf16_f32 v51, v48, v49
    ds_write_b64 v231, v[50:51] offset:16640
    v_accvgpr_read_b32 v52, a184
    v_accvgpr_read_b32 v53, a185
    v_accvgpr_read_b32 v54, a186
    v_accvgpr_read_b32 v55, a187
    v_mul_f32 v52, v52, v252
    v_mul_f32 v53, v53, v252
    v_mul_f32 v54, v54, v252
    v_mul_f32 v55, v55, v252
    v_cvt_pk_bf16_f32 v56, v52, v53
    v_cvt_pk_bf16_f32 v57, v54, v55
    ds_write_b64 v232, v[56:57] offset:16640
    v_accvgpr_read_b32 v58, a188
    v_accvgpr_read_b32 v59, a189
    v_accvgpr_read_b32 v60, a190
    v_accvgpr_read_b32 v61, a191
    v_mul_f32 v58, v58, v252
    v_mul_f32 v59, v59, v252
    v_mul_f32 v60, v60, v252
    v_mul_f32 v61, v61, v252
    v_cvt_pk_bf16_f32 v62, v58, v59
    v_cvt_pk_bf16_f32 v63, v60, v61
    ds_write_b64 v233, v[62:63] offset:16640
    s_waitcnt lgkmcnt(0)
    s_mov_b32 s39, s38
    ds_read_b128 v[112:115], v64 offset:0
    ds_read_b128 v[116:119], v65 offset:0
    ds_read_b128 v[120:123], v66 offset:0
    ds_read_b128 v[124:127], v67 offset:0
    ds_read_b128 v[128:131], v68 offset:0
    ds_read_b128 v[132:135], v69 offset:0
    ds_read_b128 v[136:139], v70 offset:0
    ds_read_b128 v[140:143], v71 offset:0
    ds_read_b128 v[144:147], v64 offset:8192
    ds_read_b128 v[148:151], v65 offset:8192
    ds_read_b128 v[152:155], v66 offset:8192
    ds_read_b128 v[156:159], v67 offset:8192
    s_waitcnt lgkmcnt(11)
    buffer_store_dwordx4 v[112:115], v11, s[16:19], s39 offen
    s_add_u32 s39, s39, 1024
    s_waitcnt lgkmcnt(10)
    buffer_store_dwordx4 v[116:119], v11, s[16:19], s39 offen
    s_add_u32 s39, s39, 1024
    s_waitcnt lgkmcnt(9)
    buffer_store_dwordx4 v[120:123], v11, s[16:19], s39 offen
    s_add_u32 s39, s39, 1024
    s_waitcnt lgkmcnt(8)
    buffer_store_dwordx4 v[124:127], v11, s[16:19], s39 offen
    s_add_u32 s39, s39, 1024
    s_waitcnt lgkmcnt(7)
    buffer_store_dwordx4 v[128:131], v11, s[16:19], s39 offen
    s_add_u32 s39, s39, 1024
    s_waitcnt lgkmcnt(6)
    buffer_store_dwordx4 v[132:135], v11, s[16:19], s39 offen
    s_add_u32 s39, s39, 1024
    s_waitcnt lgkmcnt(5)
    buffer_store_dwordx4 v[136:139], v11, s[16:19], s39 offen
    s_add_u32 s39, s39, 1024
    s_waitcnt lgkmcnt(4)
    buffer_store_dwordx4 v[140:143], v11, s[16:19], s39 offen
    s_add_u32 s39, s39, 1024
    s_waitcnt lgkmcnt(3)
    buffer_store_dwordx4 v[144:147], v11, s[16:19], s39 offen
    s_add_u32 s39, s39, 1024
    s_waitcnt lgkmcnt(2)
    buffer_store_dwordx4 v[148:151], v11, s[16:19], s39 offen
    s_add_u32 s39, s39, 1024
    s_waitcnt lgkmcnt(1)
    buffer_store_dwordx4 v[152:155], v11, s[16:19], s39 offen
    s_add_u32 s39, s39, 1024
    s_waitcnt lgkmcnt(0)
    buffer_store_dwordx4 v[156:159], v11, s[16:19], s39 offen
    s_add_u32 s39, s39, 1024
    s_waitcnt vmcnt(0)
    ds_read_b128 v[112:115], v68 offset:8192
    ds_read_b128 v[116:119], v69 offset:8192
    ds_read_b128 v[120:123], v70 offset:8192
    ds_read_b128 v[124:127], v71 offset:8192
    ds_read_b128 v[128:131], v64 offset:16384
    ds_read_b128 v[132:135], v65 offset:16384
    ds_read_b128 v[136:139], v66 offset:16384
    ds_read_b128 v[140:143], v67 offset:16384
    ds_read_b128 v[144:147], v68 offset:16384
    ds_read_b128 v[148:151], v69 offset:16384
    ds_read_b128 v[152:155], v70 offset:16384
    ds_read_b128 v[156:159], v71 offset:16384
    s_waitcnt lgkmcnt(11)
    buffer_store_dwordx4 v[112:115], v11, s[16:19], s39 offen
    s_add_u32 s39, s39, 1024
    s_waitcnt lgkmcnt(10)
    buffer_store_dwordx4 v[116:119], v11, s[16:19], s39 offen
    s_add_u32 s39, s39, 1024
    s_waitcnt lgkmcnt(9)
    buffer_store_dwordx4 v[120:123], v11, s[16:19], s39 offen
    s_add_u32 s39, s39, 1024
    s_waitcnt lgkmcnt(8)
    buffer_store_dwordx4 v[124:127], v11, s[16:19], s39 offen
    s_add_u32 s39, s39, 1024
    s_waitcnt lgkmcnt(7)
    buffer_store_dwordx4 v[128:131], v11, s[16:19], s39 offen
    s_add_u32 s39, s39, 1024
    s_waitcnt lgkmcnt(6)
    buffer_store_dwordx4 v[132:135], v11, s[16:19], s39 offen
    s_add_u32 s39, s39, 1024
    s_waitcnt lgkmcnt(5)
    buffer_store_dwordx4 v[136:139], v11, s[16:19], s39 offen
    s_add_u32 s39, s39, 1024
    s_waitcnt lgkmcnt(4)
    buffer_store_dwordx4 v[140:143], v11, s[16:19], s39 offen
    s_add_u32 s39, s39, 1024
    s_waitcnt lgkmcnt(3)
    buffer_store_dwordx4 v[144:147], v11, s[16:19], s39 offen
    s_add_u32 s39, s39, 1024
    s_waitcnt lgkmcnt(2)
    buffer_store_dwordx4 v[148:151], v11, s[16:19], s39 offen
    s_add_u32 s39, s39, 1024
    s_waitcnt lgkmcnt(1)
    buffer_store_dwordx4 v[152:155], v11, s[16:19], s39 offen
    s_add_u32 s39, s39, 1024
    s_waitcnt lgkmcnt(0)
    buffer_store_dwordx4 v[156:159], v11, s[16:19], s39 offen
    s_add_u32 s39, s39, 1024
    s_waitcnt vmcnt(0)
L_end:
    s_endpgm
L_rare0:
    s_nop 7
    s_nop 7
    v_max3_f32 v250, v112, v113, v114
    v_max3_f32 v250, v250, v115, v116
    v_max3_f32 v250, v250, v117, v118
    v_max_f32 v250, v250, v119
    v_max3_f32 v251, v120, v121, v122
    v_max3_f32 v251, v251, v123, v124
    v_max3_f32 v251, v251, v125, v126
    v_max_f32 v251, v251, v127
    v_max3_f32 v252, v128, v129, v130
    v_max3_f32 v252, v252, v131, v132
    v_max3_f32 v252, v252, v133, v134
    v_max_f32 v252, v252, v135
    ds_bpermute_b32 v2, v5, v250
    ds_bpermute_b32 v3, v5, v251
    ds_bpermute_b32 v4, v5, v252
    s_waitcnt lgkmcnt(2)
    v_max_f32 v250, v250, v2
    s_waitcnt lgkmcnt(1)
    v_max_f32 v251, v251, v3
    s_waitcnt lgkmcnt(0)
    v_max_f32 v252, v252, v4
    ds_bpermute_b32 v2, v6, v250
    ds_bpermute_b32 v3, v6, v251
    ds_bpermute_b32 v4, v6, v252
    s_waitcnt lgkmcnt(2)
    v_max_f32 v250, v250, v2
    s_waitcnt lgkmcnt(1)
    v_max_f32 v251, v251, v3
    s_waitcnt lgkmcnt(0)
    v_max_f32 v252, v252, v4
    v_mul_f32 v250, s21, v250
    v_mul_f32 v251, s21, v251
    v_mul_f32 v252, s21, v252
    v_max_f32 v250, v250, v216
    v_sub_f32 v2, v216, v250
    v_exp_f32 v2, v2
    v_mov_b32 v216, v250
    v_mul_f32 v219, v219, v2
    v_accvgpr_read_b32 v8, a0
    v_mul_f32 v8, v8, v2
    v_accvgpr_write_b32 a0, v8
    v_accvgpr_read_b32 v9, a1
    v_mul_f32 v9, v9, v2
    v_accvgpr_write_b32 a1, v9
    v_accvgpr_read_b32 v10, a2
    v_mul_f32 v10, v10, v2
    v_accvgpr_write_b32 a2, v10
    v_accvgpr_read_b32 v11, a3
    v_mul_f32 v11, v11, v2
    v_accvgpr_write_b32 a3, v11
    v_accvgpr_read_b32 v12, a4
    v_mul_f32 v12, v12, v2
    v_accvgpr_write_b32 a4, v12
    v_accvgpr_read_b32 v13, a5
    v_mul_f32 v13, v13, v2
    v_accvgpr_write_b32 a5, v13
    v_accvgpr_read_b32 v14, a6
    v_mul_f32 v14, v14, v2
    v_accvgpr_write_b32 a6, v14
    v_accvgpr_read_b32 v15, a7
    v_mul_f32 v15, v15, v2
    v_accvgpr_write_b32 a7, v15
    v_accvgpr_read_b32 v8, a8
    v_mul_f32 v8, v8, v2
    v_accvgpr_write_b32 a8, v8
    v_accvgpr_read_b32 v9, a9
    v_mul_f32 v9, v9, v2
    v_accvgpr_write_b32 a9, v9
    v_accvgpr_read_b32 v10, a10
    v_mul_f32 v10, v10, v2
    v_accvgpr_write_b32 a10, v10
    v_accvgpr_read_b32 v11, a11
    v_mul_f32 v11, v11, v2
    v_accvgpr_write_b32 a11, v11
    v_accvgpr_read_b32 v12, a12
    v_mul_f32 v12, v12, v2
    v_accvgpr_write_b32 a12, v12
    v_accvgpr_read_b32 v13, a13
    v_mul_f32 v13, v13, v2
    v_accvgpr_write_b32 a13, v13
    v_accvgpr_read_b32 v14, a14
    v_mul_f32 v14, v14, v2
    v_accvgpr_write_b32 a14, v14
    v_accvgpr_read_b32 v15, a15
    v_mul_f32 v15, v15, v2
    v_accvgpr_write_b32 a15, v15
    v_accvgpr_read_b32 v8, a16
    v_mul_f32 v8, v8, v2
    v_accvgpr_write_b32 a16, v8
    v_accvgpr_read_b32 v9, a17
    v_mul_f32 v9, v9, v2
    v_accvgpr_write_b32 a17, v9
    v_accvgpr_read_b32 v10, a18
    v_mul_f32 v10, v10, v2
    v_accvgpr_write_b32 a18, v10
    v_accvgpr_read_b32 v11, a19
    v_mul_f32 v11, v11, v2
    v_accvgpr_write_b32 a19, v11
    v_accvgpr_read_b32 v12, a20
    v_mul_f32 v12, v12, v2
    v_accvgpr_write_b32 a20, v12
    v_accvgpr_read_b32 v13, a21
    v_mul_f32 v13, v13, v2
    v_accvgpr_write_b32 a21, v13
    v_accvgpr_read_b32 v14, a22
    v_mul_f32 v14, v14, v2
    v_accvgpr_write_b32 a22, v14
    v_accvgpr_read_b32 v15, a23
    v_mul_f32 v15, v15, v2
    v_accvgpr_write_b32 a23, v15
    v_accvgpr_read_b32 v8, a24
    v_mul_f32 v8, v8, v2
    v_accvgpr_write_b32 a24, v8
    v_accvgpr_read_b32 v9, a25
    v_mul_f32 v9, v9, v2
    v_accvgpr_write_b32 a25, v9
    v_accvgpr_read_b32 v10, a26
    v_mul_f32 v10, v10, v2
    v_accvgpr_write_b32 a26, v10
    v_accvgpr_read_b32 v11, a27
    v_mul_f32 v11, v11, v2
    v_accvgpr_write_b32 a27, v11
    v_accvgpr_read_b32 v12, a28
    v_mul_f32 v12, v12, v2
    v_accvgpr_write_b32 a28, v12
    v_accvgpr_read_b32 v13, a29
    v_mul_f32 v13, v13, v2
    v_accvgpr_write_b32 a29, v13
    v_accvgpr_read_b32 v14, a30
    v_mul_f32 v14, v14, v2
    v_accvgpr_write_b32 a30, v14
    v_accvgpr_read_b32 v15, a31
    v_mul_f32 v15, v15, v2
    v_accvgpr_write_b32 a31, v15
    v_accvgpr_read_b32 v8, a32
    v_mul_f32 v8, v8, v2
    v_accvgpr_write_b32 a32, v8
    v_accvgpr_read_b32 v9, a33
    v_mul_f32 v9, v9, v2
    v_accvgpr_write_b32 a33, v9
    v_accvgpr_read_b32 v10, a34
    v_mul_f32 v10, v10, v2
    v_accvgpr_write_b32 a34, v10
    v_accvgpr_read_b32 v11, a35
    v_mul_f32 v11, v11, v2
    v_accvgpr_write_b32 a35, v11
    v_accvgpr_read_b32 v12, a36
    v_mul_f32 v12, v12, v2
    v_accvgpr_write_b32 a36, v12
    v_accvgpr_read_b32 v13, a37
    v_mul_f32 v13, v13, v2
    v_accvgpr_write_b32 a37, v13
    v_accvgpr_read_b32 v14, a38
    v_mul_f32 v14, v14, v2
    v_accvgpr_write_b32 a38, v14
    v_accvgpr_read_b32 v15, a39
    v_mul_f32 v15, v15, v2
    v_accvgpr_write_b32 a39, v15
    v_accvgpr_read_b32 v8, a40
    v_mul_f32 v8, v8, v2
    v_accvgpr_write_b32 a40, v8
    v_accvgpr_read_b32 v9, a41
    v_mul_f32 v9, v9, v2
    v_accvgpr_write_b32 a41, v9
    v_accvgpr_read_b32 v10, a42
    v_mul_f32 v10, v10, v2
    v_accvgpr_write_b32 a42, v10
    v_accvgpr_read_b32 v11, a43
    v_mul_f32 v11, v11, v2
    v_accvgpr_write_b32 a43, v11
    v_accvgpr_read_b32 v12, a44
    v_mul_f32 v12, v12, v2
    v_accvgpr_write_b32 a44, v12
    v_accvgpr_read_b32 v13, a45
    v_mul_f32 v13, v13, v2
    v_accvgpr_write_b32 a45, v13
    v_accvgpr_read_b32 v14, a46
    v_mul_f32 v14, v14, v2
    v_accvgpr_write_b32 a46, v14
    v_accvgpr_read_b32 v15, a47
    v_mul_f32 v15, v15, v2
    v_accvgpr_write_b32 a47, v15
    v_accvgpr_read_b32 v8, a48
    v_mul_f32 v8, v8, v2
    v_accvgpr_write_b32 a48, v8
    v_accvgpr_read_b32 v9, a49
    v_mul_f32 v9, v9, v2
    v_accvgpr_write_b32 a49, v9
    v_accvgpr_read_b32 v10, a50
    v_mul_f32 v10, v10, v2
    v_accvgpr_write_b32 a50, v10
    v_accvgpr_read_b32 v11, a51
    v_mul_f32 v11, v11, v2
    v_accvgpr_write_b32 a51, v11
    v_accvgpr_read_b32 v12, a52
    v_mul_f32 v12, v12, v2
    v_accvgpr_write_b32 a52, v12
    v_accvgpr_read_b32 v13, a53
    v_mul_f32 v13, v13, v2
    v_accvgpr_write_b32 a53, v13
    v_accvgpr_read_b32 v14, a54
    v_mul_f32 v14, v14, v2
    v_accvgpr_write_b32 a54, v14
    v_accvgpr_read_b32 v15, a55
    v_mul_f32 v15, v15, v2
    v_accvgpr_write_b32 a55, v15
    v_accvgpr_read_b32 v8, a56
    v_mul_f32 v8, v8, v2
    v_accvgpr_write_b32 a56, v8
    v_accvgpr_read_b32 v9, a57
    v_mul_f32 v9, v9, v2
    v_accvgpr_write_b32 a57, v9
    v_accvgpr_read_b32 v10, a58
    v_mul_f32 v10, v10, v2
    v_accvgpr_write_b32 a58, v10
    v_accvgpr_read_b32 v11, a59
    v_mul_f32 v11, v11, v2
    v_accvgpr_write_b32 a59, v11
    v_accvgpr_read_b32 v12, a60
    v_mul_f32 v12, v12, v2
    v_accvgpr_write_b32 a60, v12
    v_accvgpr_read_b32 v13, a61
    v_mul_f32 v13, v13, v2
    v_accvgpr_write_b32 a61, v13
    v_accvgpr_read_b32 v14, a62
    v_mul_f32 v14, v14, v2
    v_accvgpr_write_b32 a62, v14
    v_accvgpr_read_b32 v15, a63
    v_mul_f32 v15, v15, v2
    v_accvgpr_write_b32 a63, v15
    v_max_f32 v251, v251, v217
    v_sub_f32 v3, v217, v251
    v_exp_f32 v3, v3
    v_mov_b32 v217, v251
    v_mul_f32 v220, v220, v3
    v_accvgpr_read_b32 v8, a64
    v_mul_f32 v8, v8, v3
    v_accvgpr_write_b32 a64, v8
    v_accvgpr_read_b32 v9, a65
    v_mul_f32 v9, v9, v3
    v_accvgpr_write_b32 a65, v9
    v_accvgpr_read_b32 v10, a66
    v_mul_f32 v10, v10, v3
    v_accvgpr_write_b32 a66, v10
    v_accvgpr_read_b32 v11, a67
    v_mul_f32 v11, v11, v3
    v_accvgpr_write_b32 a67, v11
    v_accvgpr_read_b32 v12, a68
    v_mul_f32 v12, v12, v3
    v_accvgpr_write_b32 a68, v12
    v_accvgpr_read_b32 v13, a69
    v_mul_f32 v13, v13, v3
    v_accvgpr_write_b32 a69, v13
    v_accvgpr_read_b32 v14, a70
    v_mul_f32 v14, v14, v3
    v_accvgpr_write_b32 a70, v14
    v_accvgpr_read_b32 v15, a71
    v_mul_f32 v15, v15, v3
    v_accvgpr_write_b32 a71, v15
    v_accvgpr_read_b32 v8, a72
    v_mul_f32 v8, v8, v3
    v_accvgpr_write_b32 a72, v8
    v_accvgpr_read_b32 v9, a73
    v_mul_f32 v9, v9, v3
    v_accvgpr_write_b32 a73, v9
    v_accvgpr_read_b32 v10, a74
    v_mul_f32 v10, v10, v3
    v_accvgpr_write_b32 a74, v10
    v_accvgpr_read_b32 v11, a75
    v_mul_f32 v11, v11, v3
    v_accvgpr_write_b32 a75, v11
    v_accvgpr_read_b32 v12, a76
    v_mul_f32 v12, v12, v3
    v_accvgpr_write_b32 a76, v12
    v_accvgpr_read_b32 v13, a77
    v_mul_f32 v13, v13, v3
    v_accvgpr_write_b32 a77, v13
    v_accvgpr_read_b32 v14, a78
    v_mul_f32 v14, v14, v3
    v_accvgpr_write_b32 a78, v14
    v_accvgpr_read_b32 v15, a79
    v_mul_f32 v15, v15, v3
    v_accvgpr_write_b32 a79, v15
    v_accvgpr_read_b32 v8, a80
    v_mul_f32 v8, v8, v3
    v_accvgpr_write_b32 a80, v8
    v_accvgpr_read_b32 v9, a81
    v_mul_f32 v9, v9, v3
    v_accvgpr_write_b32 a81, v9
    v_accvgpr_read_b32 v10, a82
    v_mul_f32 v10, v10, v3
    v_accvgpr_write_b32 a82, v10
    v_accvgpr_read_b32 v11, a83
    v_mul_f32 v11, v11, v3
    v_accvgpr_write_b32 a83, v11
    v_accvgpr_read_b32 v12, a84
    v_mul_f32 v12, v12, v3
    v_accvgpr_write_b32 a84, v12
    v_accvgpr_read_b32 v13, a85
    v_mul_f32 v13, v13, v3
    v_accvgpr_write_b32 a85, v13
    v_accvgpr_read_b32 v14, a86
    v_mul_f32 v14, v14, v3
    v_accvgpr_write_b32 a86, v14
    v_accvgpr_read_b32 v15, a87
    v_mul_f32 v15, v15, v3
    v_accvgpr_write_b32 a87, v15
    v_accvgpr_read_b32 v8, a88
    v_mul_f32 v8, v8, v3
    v_accvgpr_write_b32 a88, v8
    v_accvgpr_read_b32 v9, a89
    v_mul_f32 v9, v9, v3
    v_accvgpr_write_b32 a89, v9
    v_accvgpr_read_b32 v10, a90
    v_mul_f32 v10, v10, v3
    v_accvgpr_write_b32 a90, v10
    v_accvgpr_read_b32 v11, a91
    v_mul_f32 v11, v11, v3
    v_accvgpr_write_b32 a91, v11
    v_accvgpr_read_b32 v12, a92
    v_mul_f32 v12, v12, v3
    v_accvgpr_write_b32 a92, v12
    v_accvgpr_read_b32 v13, a93
    v_mul_f32 v13, v13, v3
    v_accvgpr_write_b32 a93, v13
    v_accvgpr_read_b32 v14, a94
    v_mul_f32 v14, v14, v3
    v_accvgpr_write_b32 a94, v14
    v_accvgpr_read_b32 v15, a95
    v_mul_f32 v15, v15, v3
    v_accvgpr_write_b32 a95, v15
    v_accvgpr_read_b32 v8, a96
    v_mul_f32 v8, v8, v3
    v_accvgpr_write_b32 a96, v8
    v_accvgpr_read_b32 v9, a97
    v_mul_f32 v9, v9, v3
    v_accvgpr_write_b32 a97, v9
    v_accvgpr_read_b32 v10, a98
    v_mul_f32 v10, v10, v3
    v_accvgpr_write_b32 a98, v10
    v_accvgpr_read_b32 v11, a99
    v_mul_f32 v11, v11, v3
    v_accvgpr_write_b32 a99, v11
    v_accvgpr_read_b32 v12, a100
    v_mul_f32 v12, v12, v3
    v_accvgpr_write_b32 a100, v12
    v_accvgpr_read_b32 v13, a101
    v_mul_f32 v13, v13, v3
    v_accvgpr_write_b32 a101, v13
    v_accvgpr_read_b32 v14, a102
    v_mul_f32 v14, v14, v3
    v_accvgpr_write_b32 a102, v14
    v_accvgpr_read_b32 v15, a103
    v_mul_f32 v15, v15, v3
    v_accvgpr_write_b32 a103, v15
    v_accvgpr_read_b32 v8, a104
    v_mul_f32 v8, v8, v3
    v_accvgpr_write_b32 a104, v8
    v_accvgpr_read_b32 v9, a105
    v_mul_f32 v9, v9, v3
    v_accvgpr_write_b32 a105, v9
    v_accvgpr_read_b32 v10, a106
    v_mul_f32 v10, v10, v3
    v_accvgpr_write_b32 a106, v10
    v_accvgpr_read_b32 v11, a107
    v_mul_f32 v11, v11, v3
    v_accvgpr_write_b32 a107, v11
    v_accvgpr_read_b32 v12, a108
    v_mul_f32 v12, v12, v3
    v_accvgpr_write_b32 a108, v12
    v_accvgpr_read_b32 v13, a109
    v_mul_f32 v13, v13, v3
    v_accvgpr_write_b32 a109, v13
    v_accvgpr_read_b32 v14, a110
    v_mul_f32 v14, v14, v3
    v_accvgpr_write_b32 a110, v14
    v_accvgpr_read_b32 v15, a111
    v_mul_f32 v15, v15, v3
    v_accvgpr_write_b32 a111, v15
    v_accvgpr_read_b32 v8, a112
    v_mul_f32 v8, v8, v3
    v_accvgpr_write_b32 a112, v8
    v_accvgpr_read_b32 v9, a113
    v_mul_f32 v9, v9, v3
    v_accvgpr_write_b32 a113, v9
    v_accvgpr_read_b32 v10, a114
    v_mul_f32 v10, v10, v3
    v_accvgpr_write_b32 a114, v10
    v_accvgpr_read_b32 v11, a115
    v_mul_f32 v11, v11, v3
    v_accvgpr_write_b32 a115, v11
    v_accvgpr_read_b32 v12, a116
    v_mul_f32 v12, v12, v3
    v_accvgpr_write_b32 a116, v12
    v_accvgpr_read_b32 v13, a117
    v_mul_f32 v13, v13, v3
    v_accvgpr_write_b32 a117, v13
    v_accvgpr_read_b32 v14, a118
    v_mul_f32 v14, v14, v3
    v_accvgpr_write_b32 a118, v14
    v_accvgpr_read_b32 v15, a119
    v_mul_f32 v15, v15, v3
    v_accvgpr_write_b32 a119, v15
    v_accvgpr_read_b32 v8, a120
    v_mul_f32 v8, v8, v3
    v_accvgpr_write_b32 a120, v8
    v_accvgpr_read_b32 v9, a121
    v_mul_f32 v9, v9, v3
    v_accvgpr_write_b32 a121, v9
    v_accvgpr_read_b32 v10, a122
    v_mul_f32 v10, v10, v3
    v_accvgpr_write_b32 a122, v10
    v_accvgpr_read_b32 v11, a123
    v_mul_f32 v11, v11, v3
    v_accvgpr_write_b32 a123, v11
    v_accvgpr_read_b32 v12, a124
    v_mul_f32 v12, v12, v3
    v_accvgpr_write_b32 a124, v12
    v_accvgpr_read_b32 v13, a125
    v_mul_f32 v13, v13, v3
    v_accvgpr_write_b32 a125, v13
    v_accvgpr_read_b32 v14, a126
    v_mul_f32 v14, v14, v3
    v_accvgpr_write_b32 a126, v14
    v_accvgpr_read_b32 v15, a127
    v_mul_f32 v15, v15, v3
    v_accvgpr_write_b32 a127, v15
    v_max_f32 v252, v252, v218
    v_sub_f32 v4, v218, v252
    v_exp_f32 v4, v4
    v_mov_b32 v218, v252
    v_mul_f32 v221, v221, v4
    v_accvgpr_read_b32 v8, a128
    v_mul_f32 v8, v8, v4
    v_accvgpr_write_b32 a128, v8
    v_accvgpr_read_b32 v9, a129
    v_mul_f32 v9, v9, v4
    v_accvgpr_write_b32 a129, v9
    v_accvgpr_read_b32 v10, a130
    v_mul_f32 v10, v10, v4
    v_accvgpr_write_b32 a130, v10
    v_accvgpr_read_b32 v11, a131
    v_mul_f32 v11, v11, v4
    v_accvgpr_write_b32 a131, v11
    v_accvgpr_read_b32 v12, a132
    v_mul_f32 v12, v12, v4
    v_accvgpr_write_b32 a132, v12
    v_accvgpr_read_b32 v13, a133
    v_mul_f32 v13, v13, v4
    v_accvgpr_write_b32 a133, v13
    v_accvgpr_read_b32 v14, a134
    v_mul_f32 v14, v14, v4
    v_accvgpr_write_b32 a134, v14
    v_accvgpr_read_b32 v15, a135
    v_mul_f32 v15, v15, v4
    v_accvgpr_write_b32 a135, v15
    v_accvgpr_read_b32 v8, a136
    v_mul_f32 v8, v8, v4
    v_accvgpr_write_b32 a136, v8
    v_accvgpr_read_b32 v9, a137
    v_mul_f32 v9, v9, v4
    v_accvgpr_write_b32 a137, v9
    v_accvgpr_read_b32 v10, a138
    v_mul_f32 v10, v10, v4
    v_accvgpr_write_b32 a138, v10
    v_accvgpr_read_b32 v11, a139
    v_mul_f32 v11, v11, v4
    v_accvgpr_write_b32 a139, v11
    v_accvgpr_read_b32 v12, a140
    v_mul_f32 v12, v12, v4
    v_accvgpr_write_b32 a140, v12
    v_accvgpr_read_b32 v13, a141
    v_mul_f32 v13, v13, v4
    v_accvgpr_write_b32 a141, v13
    v_accvgpr_read_b32 v14, a142
    v_mul_f32 v14, v14, v4
    v_accvgpr_write_b32 a142, v14
    v_accvgpr_read_b32 v15, a143
    v_mul_f32 v15, v15, v4
    v_accvgpr_write_b32 a143, v15
    v_accvgpr_read_b32 v8, a144
    v_mul_f32 v8, v8, v4
    v_accvgpr_write_b32 a144, v8
    v_accvgpr_read_b32 v9, a145
    v_mul_f32 v9, v9, v4
    v_accvgpr_write_b32 a145, v9
    v_accvgpr_read_b32 v10, a146
    v_mul_f32 v10, v10, v4
    v_accvgpr_write_b32 a146, v10
    v_accvgpr_read_b32 v11, a147
    v_mul_f32 v11, v11, v4
    v_accvgpr_write_b32 a147, v11
    v_accvgpr_read_b32 v12, a148
    v_mul_f32 v12, v12, v4
    v_accvgpr_write_b32 a148, v12
    v_accvgpr_read_b32 v13, a149
    v_mul_f32 v13, v13, v4
    v_accvgpr_write_b32 a149, v13
    v_accvgpr_read_b32 v14, a150
    v_mul_f32 v14, v14, v4
    v_accvgpr_write_b32 a150, v14
    v_accvgpr_read_b32 v15, a151
    v_mul_f32 v15, v15, v4
    v_accvgpr_write_b32 a151, v15
    v_accvgpr_read_b32 v8, a152
    v_mul_f32 v8, v8, v4
    v_accvgpr_write_b32 a152, v8
    v_accvgpr_read_b32 v9, a153
    v_mul_f32 v9, v9, v4
    v_accvgpr_write_b32 a153, v9
    v_accvgpr_read_b32 v10, a154
    v_mul_f32 v10, v10, v4
    v_accvgpr_write_b32 a154, v10
    v_accvgpr_read_b32 v11, a155
    v_mul_f32 v11, v11, v4
    v_accvgpr_write_b32 a155, v11
    v_accvgpr_read_b32 v12, a156
    v_mul_f32 v12, v12, v4
    v_accvgpr_write_b32 a156, v12
    v_accvgpr_read_b32 v13, a157
    v_mul_f32 v13, v13, v4
    v_accvgpr_write_b32 a157, v13
    v_accvgpr_read_b32 v14, a158
    v_mul_f32 v14, v14, v4
    v_accvgpr_write_b32 a158, v14
    v_accvgpr_read_b32 v15, a159
    v_mul_f32 v15, v15, v4
    v_accvgpr_write_b32 a159, v15
    v_accvgpr_read_b32 v8, a160
    v_mul_f32 v8, v8, v4
    v_accvgpr_write_b32 a160, v8
    v_accvgpr_read_b32 v9, a161
    v_mul_f32 v9, v9, v4
    v_accvgpr_write_b32 a161, v9
    v_accvgpr_read_b32 v10, a162
    v_mul_f32 v10, v10, v4
    v_accvgpr_write_b32 a162, v10
    v_accvgpr_read_b32 v11, a163
    v_mul_f32 v11, v11, v4
    v_accvgpr_write_b32 a163, v11
    v_accvgpr_read_b32 v12, a164
    v_mul_f32 v12, v12, v4
    v_accvgpr_write_b32 a164, v12
    v_accvgpr_read_b32 v13, a165
    v_mul_f32 v13, v13, v4
    v_accvgpr_write_b32 a165, v13
    v_accvgpr_read_b32 v14, a166
    v_mul_f32 v14, v14, v4
    v_accvgpr_write_b32 a166, v14
    v_accvgpr_read_b32 v15, a167
    v_mul_f32 v15, v15, v4
    v_accvgpr_write_b32 a167, v15
    v_accvgpr_read_b32 v8, a168
    v_mul_f32 v8, v8, v4
    v_accvgpr_write_b32 a168, v8
    v_accvgpr_read_b32 v9, a169
    v_mul_f32 v9, v9, v4
    v_accvgpr_write_b32 a169, v9
    v_accvgpr_read_b32 v10, a170
    v_mul_f32 v10, v10, v4
    v_accvgpr_write_b32 a170, v10
    v_accvgpr_read_b32 v11, a171
    v_mul_f32 v11, v11, v4
    v_accvgpr_write_b32 a171, v11
    v_accvgpr_read_b32 v12, a172
    v_mul_f32 v12, v12, v4
    v_accvgpr_write_b32 a172, v12
    v_accvgpr_read_b32 v13, a173
    v_mul_f32 v13, v13, v4
    v_accvgpr_write_b32 a173, v13
    v_accvgpr_read_b32 v14, a174
    v_mul_f32 v14, v14, v4
    v_accvgpr_write_b32 a174, v14
    v_accvgpr_read_b32 v15, a175
    v_mul_f32 v15, v15, v4
    v_accvgpr_write_b32 a175, v15
    v_accvgpr_read_b32 v8, a176
    v_mul_f32 v8, v8, v4
    v_accvgpr_write_b32 a176, v8
    v_accvgpr_read_b32 v9, a177
    v_mul_f32 v9, v9, v4
    v_accvgpr_write_b32 a177, v9
    v_accvgpr_read_b32 v10, a178
    v_mul_f32 v10, v10, v4
    v_accvgpr_write_b32 a178, v10
    v_accvgpr_read_b32 v11, a179
    v_mul_f32 v11, v11, v4
    v_accvgpr_write_b32 a179, v11
    v_accvgpr_read_b32 v12, a180
    v_mul_f32 v12, v12, v4
    v_accvgpr_write_b32 a180, v12
    v_accvgpr_read_b32 v13, a181
    v_mul_f32 v13, v13, v4
    v_accvgpr_write_b32 a181, v13
    v_accvgpr_read_b32 v14, a182
    v_mul_f32 v14, v14, v4
    v_accvgpr_write_b32 a182, v14
    v_accvgpr_read_b32 v15, a183
    v_mul_f32 v15, v15, v4
    v_accvgpr_write_b32 a183, v15
    v_accvgpr_read_b32 v8, a184
    v_mul_f32 v8, v8, v4
    v_accvgpr_write_b32 a184, v8
    v_accvgpr_read_b32 v9, a185
    v_mul_f32 v9, v9, v4
    v_accvgpr_write_b32 a185, v9
    v_accvgpr_read_b32 v10, a186
    v_mul_f32 v10, v10, v4
    v_accvgpr_write_b32 a186, v10
    v_accvgpr_read_b32 v11, a187
    v_mul_f32 v11, v11, v4
    v_accvgpr_write_b32 a187, v11
    v_accvgpr_read_b32 v12, a188
    v_mul_f32 v12, v12, v4
    v_accvgpr_write_b32 a188, v12
    v_accvgpr_read_b32 v13, a189
    v_mul_f32 v13, v13, v4
    v_accvgpr_write_b32 a189, v13
    v_accvgpr_read_b32 v14, a190
    v_mul_f32 v14, v14, v4
    v_accvgpr_write_b32 a190, v14
    v_accvgpr_read_b32 v15, a191
    v_mul_f32 v15, v15, v4
    v_accvgpr_write_b32 a191, v15
    v_fma_f32 v184, v112, s21, -v216
    v_exp_f32 v184, v184
    v_fma_f32 v185, v113, s21, -v216
    v_exp_f32 v185, v185
    v_fma_f32 v186, v114, s21, -v216
    v_exp_f32 v186, v186
    v_fma_f32 v187, v115, s21, -v216
    v_exp_f32 v187, v187
    v_fma_f32 v188, v120, s21, -v217
    v_exp_f32 v188, v188
    v_fma_f32 v189, v121, s21, -v217
    v_exp_f32 v189, v189
    v_fma_f32 v190, v122, s21, -v217
    v_exp_f32 v190, v190
    v_fma_f32 v191, v123, s21, -v217
    v_exp_f32 v191, v191
    v_fma_f32 v192, v116, s21, -v216
    v_exp_f32 v192, v192
    v_fma_f32 v193, v117, s21, -v216
    v_exp_f32 v193, v193
    v_fma_f32 v194, v118, s21, -v216
    v_exp_f32 v194, v194
    v_fma_f32 v195, v119, s21, -v216
    v_exp_f32 v195, v195
    v_fma_f32 v196, v124, s21, -v217
    v_exp_f32 v196, v196
    v_fma_f32 v197, v125, s21, -v217
    v_exp_f32 v197, v197
    v_fma_f32 v198, v126, s21, -v217
    v_exp_f32 v198, v198
    v_fma_f32 v199, v127, s21, -v217
    v_exp_f32 v199, v199
    v_fma_f32 v242, v128, s21, -v218
    v_exp_f32 v242, v242
    v_fma_f32 v243, v129, s21, -v218
    v_exp_f32 v243, v243
    v_fma_f32 v244, v130, s21, -v218
    v_exp_f32 v244, v244
    v_fma_f32 v245, v131, s21, -v218
    v_exp_f32 v245, v245
    v_fma_f32 v246, v132, s21, -v218
    v_exp_f32 v246, v246
    v_fma_f32 v247, v133, s21, -v218
    v_exp_f32 v247, v247
    v_fma_f32 v248, v134, s21, -v218
    v_exp_f32 v248, v248
    v_fma_f32 v249, v135, s21, -v218
    v_exp_f32 v249, v249
    v_cvt_pk_bf16_f32 v160, v184, v185
    v_cvt_pk_bf16_f32 v161, v186, v187
    v_cvt_pk_bf16_f32 v164, v188, v189
    v_cvt_pk_bf16_f32 v165, v190, v191
    v_cvt_pk_bf16_f32 v162, v192, v193
    v_cvt_pk_bf16_f32 v163, v194, v195
    v_cvt_pk_bf16_f32 v166, v196, v197
    v_cvt_pk_bf16_f32 v167, v198, v199
    v_cvt_pk_bf16_f32 v168, v242, v243
    v_cvt_pk_bf16_f32 v169, v244, v245
    v_cvt_pk_bf16_f32 v170, v246, v247
    v_cvt_pk_bf16_f32 v171, v248, v249
    v_mfma_f32_16x16x32_bf16 v[200:203], v[212:215], v[160:163], 0
    v_mfma_f32_16x16x32_bf16 v[204:207], v[212:215], v[164:167], 0
    v_mfma_f32_16x16x32_bf16 v[208:211], v[212:215], v[168:171], 0
    s_nop 7
    s_nop 7
    s_setpc_b64 s[44:45]
L_rare1:
    s_nop 7
    s_nop 7
    v_max3_f32 v250, v136, v137, v138
    v_max3_f32 v250, v250, v139, v140
    v_max3_f32 v250, v250, v141, v142
    v_max_f32 v250, v250, v143
    v_max3_f32 v251, v144, v145, v146
    v_max3_f32 v251, v251, v147, v148
    v_max3_f32 v251, v251, v149, v150
    v_max_f32 v251, v251, v151
    v_max3_f32 v252, v152, v153, v154
    v_max3_f32 v252, v252, v155, v156
    v_max3_f32 v252, v252, v157, v158
    v_max_f32 v252, v252, v159
    ds_bpermute_b32 v2, v5, v250
    ds_bpermute_b32 v3, v5, v251
    ds_bpermute_b32 v4, v5, v252
    s_waitcnt lgkmcnt(2)
    v_max_f32 v250, v250, v2
    s_waitcnt lgkmcnt(1)
    v_max_f32 v251, v251, v3
    s_waitcnt lgkmcnt(0)
    v_max_f32 v252, v252, v4
    ds_bpermute_b32 v2, v6, v250
    ds_bpermute_b32 v3, v6, v251
    ds_bpermute_b32 v4, v6, v252
    s_waitcnt lgkmcnt(2)
    v_max_f32 v250, v250, v2
    s_waitcnt lgkmcnt(1)
    v_max_f32 v251, v251, v3
    s_waitcnt lgkmcnt(0)
    v_max_f32 v252, v252, v4
    v_mul_f32 v250, s21, v250
    v_mul_f32 v251, s21, v251
    v_mul_f32 v252, s21, v252
    v_max_f32 v250, v250, v216
    v_sub_f32 v2, v216, v250
    v_exp_f32 v2, v2
    v_mov_b32 v216, v250
    v_mul_f32 v219, v219, v2
    v_accvgpr_read_b32 v8, a0
    v_mul_f32 v8, v8, v2
    v_accvgpr_write_b32 a0, v8
    v_accvgpr_read_b32 v9, a1
    v_mul_f32 v9, v9, v2
    v_accvgpr_write_b32 a1, v9
    v_accvgpr_read_b32 v10, a2
    v_mul_f32 v10, v10, v2
    v_accvgpr_write_b32 a2, v10
    v_accvgpr_read_b32 v11, a3
    v_mul_f32 v11, v11, v2
    v_accvgpr_write_b32 a3, v11
    v_accvgpr_read_b32 v12, a4
    v_mul_f32 v12, v12, v2
    v_accvgpr_write_b32 a4, v12
    v_accvgpr_read_b32 v13, a5
    v_mul_f32 v13, v13, v2
    v_accvgpr_write_b32 a5, v13
    v_accvgpr_read_b32 v14, a6
    v_mul_f32 v14, v14, v2
    v_accvgpr_write_b32 a6, v14
    v_accvgpr_read_b32 v15, a7
    v_mul_f32 v15, v15, v2
    v_accvgpr_write_b32 a7, v15
    v_accvgpr_read_b32 v8, a8
    v_mul_f32 v8, v8, v2
    v_accvgpr_write_b32 a8, v8
    v_accvgpr_read_b32 v9, a9
    v_mul_f32 v9, v9, v2
    v_accvgpr_write_b32 a9, v9
    v_accvgpr_read_b32 v10, a10
    v_mul_f32 v10, v10, v2
    v_accvgpr_write_b32 a10, v10
    v_accvgpr_read_b32 v11, a11
    v_mul_f32 v11, v11, v2
    v_accvgpr_write_b32 a11, v11
    v_accvgpr_read_b32 v12, a12
    v_mul_f32 v12, v12, v2
    v_accvgpr_write_b32 a12, v12
    v_accvgpr_read_b32 v13, a13
    v_mul_f32 v13, v13, v2
    v_accvgpr_write_b32 a13, v13
    v_accvgpr_read_b32 v14, a14
    v_mul_f32 v14, v14, v2
    v_accvgpr_write_b32 a14, v14
    v_accvgpr_read_b32 v15, a15
    v_mul_f32 v15, v15, v2
    v_accvgpr_write_b32 a15, v15
    v_accvgpr_read_b32 v8, a16
    v_mul_f32 v8, v8, v2
    v_accvgpr_write_b32 a16, v8
    v_accvgpr_read_b32 v9, a17
    v_mul_f32 v9, v9, v2
    v_accvgpr_write_b32 a17, v9
    v_accvgpr_read_b32 v10, a18
    v_mul_f32 v10, v10, v2
    v_accvgpr_write_b32 a18, v10
    v_accvgpr_read_b32 v11, a19
    v_mul_f32 v11, v11, v2
    v_accvgpr_write_b32 a19, v11
    v_accvgpr_read_b32 v12, a20
    v_mul_f32 v12, v12, v2
    v_accvgpr_write_b32 a20, v12
    v_accvgpr_read_b32 v13, a21
    v_mul_f32 v13, v13, v2
    v_accvgpr_write_b32 a21, v13
    v_accvgpr_read_b32 v14, a22
    v_mul_f32 v14, v14, v2
    v_accvgpr_write_b32 a22, v14
    v_accvgpr_read_b32 v15, a23
    v_mul_f32 v15, v15, v2
    v_accvgpr_write_b32 a23, v15
    v_accvgpr_read_b32 v8, a24
    v_mul_f32 v8, v8, v2
    v_accvgpr_write_b32 a24, v8
    v_accvgpr_read_b32 v9, a25
    v_mul_f32 v9, v9, v2
    v_accvgpr_write_b32 a25, v9
    v_accvgpr_read_b32 v10, a26
    v_mul_f32 v10, v10, v2
    v_accvgpr_write_b32 a26, v10
    v_accvgpr_read_b32 v11, a27
    v_mul_f32 v11, v11, v2
    v_accvgpr_write_b32 a27, v11
    v_accvgpr_read_b32 v12, a28
    v_mul_f32 v12, v12, v2
    v_accvgpr_write_b32 a28, v12
    v_accvgpr_read_b32 v13, a29
    v_mul_f32 v13, v13, v2
    v_accvgpr_write_b32 a29, v13
    v_accvgpr_read_b32 v14, a30
    v_mul_f32 v14, v14, v2
    v_accvgpr_write_b32 a30, v14
    v_accvgpr_read_b32 v15, a31
    v_mul_f32 v15, v15, v2
    v_accvgpr_write_b32 a31, v15
    v_accvgpr_read_b32 v8, a32
    v_mul_f32 v8, v8, v2
    v_accvgpr_write_b32 a32, v8
    v_accvgpr_read_b32 v9, a33
    v_mul_f32 v9, v9, v2
    v_accvgpr_write_b32 a33, v9
    v_accvgpr_read_b32 v10, a34
    v_mul_f32 v10, v10, v2
    v_accvgpr_write_b32 a34, v10
    v_accvgpr_read_b32 v11, a35
    v_mul_f32 v11, v11, v2
    v_accvgpr_write_b32 a35, v11
    v_accvgpr_read_b32 v12, a36
    v_mul_f32 v12, v12, v2
    v_accvgpr_write_b32 a36, v12
    v_accvgpr_read_b32 v13, a37
    v_mul_f32 v13, v13, v2
    v_accvgpr_write_b32 a37, v13
    v_accvgpr_read_b32 v14, a38
    v_mul_f32 v14, v14, v2
    v_accvgpr_write_b32 a38, v14
    v_accvgpr_read_b32 v15, a39
    v_mul_f32 v15, v15, v2
    v_accvgpr_write_b32 a39, v15
    v_accvgpr_read_b32 v8, a40
    v_mul_f32 v8, v8, v2
    v_accvgpr_write_b32 a40, v8
    v_accvgpr_read_b32 v9, a41
    v_mul_f32 v9, v9, v2
    v_accvgpr_write_b32 a41, v9
    v_accvgpr_read_b32 v10, a42
    v_mul_f32 v10, v10, v2
    v_accvgpr_write_b32 a42, v10
    v_accvgpr_read_b32 v11, a43
    v_mul_f32 v11, v11, v2
    v_accvgpr_write_b32 a43, v11
    v_accvgpr_read_b32 v12, a44
    v_mul_f32 v12, v12, v2
    v_accvgpr_write_b32 a44, v12
    v_accvgpr_read_b32 v13, a45
    v_mul_f32 v13, v13, v2
    v_accvgpr_write_b32 a45, v13
    v_accvgpr_read_b32 v14, a46
    v_mul_f32 v14, v14, v2
    v_accvgpr_write_b32 a46, v14
    v_accvgpr_read_b32 v15, a47
    v_mul_f32 v15, v15, v2
    v_accvgpr_write_b32 a47, v15
    v_accvgpr_read_b32 v8, a48
    v_mul_f32 v8, v8, v2
    v_accvgpr_write_b32 a48, v8
    v_accvgpr_read_b32 v9, a49
    v_mul_f32 v9, v9, v2
    v_accvgpr_write_b32 a49, v9
    v_accvgpr_read_b32 v10, a50
    v_mul_f32 v10, v10, v2
    v_accvgpr_write_b32 a50, v10
    v_accvgpr_read_b32 v11, a51
    v_mul_f32 v11, v11, v2
    v_accvgpr_write_b32 a51, v11
    v_accvgpr_read_b32 v12, a52
    v_mul_f32 v12, v12, v2
    v_accvgpr_write_b32 a52, v12
    v_accvgpr_read_b32 v13, a53
    v_mul_f32 v13, v13, v2
    v_accvgpr_write_b32 a53, v13
    v_accvgpr_read_b32 v14, a54
    v_mul_f32 v14, v14, v2
    v_accvgpr_write_b32 a54, v14
    v_accvgpr_read_b32 v15, a55
    v_mul_f32 v15, v15, v2
    v_accvgpr_write_b32 a55, v15
    v_accvgpr_read_b32 v8, a56
    v_mul_f32 v8, v8, v2
    v_accvgpr_write_b32 a56, v8
    v_accvgpr_read_b32 v9, a57
    v_mul_f32 v9, v9, v2
    v_accvgpr_write_b32 a57, v9
    v_accvgpr_read_b32 v10, a58
    v_mul_f32 v10, v10, v2
    v_accvgpr_write_b32 a58, v10
    v_accvgpr_read_b32 v11, a59
    v_mul_f32 v11, v11, v2
    v_accvgpr_write_b32 a59, v11
    v_accvgpr_read_b32 v12, a60
    v_mul_f32 v12, v12, v2
    v_accvgpr_write_b32 a60, v12
    v_accvgpr_read_b32 v13, a61
    v_mul_f32 v13, v13, v2
    v_accvgpr_write_b32 a61, v13
    v_accvgpr_read_b32 v14, a62
    v_mul_f32 v14, v14, v2
    v_accvgpr_write_b32 a62, v14
    v_accvgpr_read_b32 v15, a63
    v_mul_f32 v15, v15, v2
    v_accvgpr_write_b32 a63, v15
    v_max_f32 v251, v251, v217
    v_sub_f32 v3, v217, v251
    v_exp_f32 v3, v3
    v_mov_b32 v217, v251
    v_mul_f32 v220, v220, v3
    v_accvgpr_read_b32 v8, a64
    v_mul_f32 v8, v8, v3
    v_accvgpr_write_b32 a64, v8
    v_accvgpr_read_b32 v9, a65
    v_mul_f32 v9, v9, v3
    v_accvgpr_write_b32 a65, v9
    v_accvgpr_read_b32 v10, a66
    v_mul_f32 v10, v10, v3
    v_accvgpr_write_b32 a66, v10
    v_accvgpr_read_b32 v11, a67
    v_mul_f32 v11, v11, v3
    v_accvgpr_write_b32 a67, v11
    v_accvgpr_read_b32 v12, a68
    v_mul_f32 v12, v12, v3
    v_accvgpr_write_b32 a68, v12
    v_accvgpr_read_b32 v13, a69
    v_mul_f32 v13, v13, v3
    v_accvgpr_write_b32 a69, v13
    v_accvgpr_read_b32 v14, a70
    v_mul_f32 v14, v14, v3
    v_accvgpr_write_b32 a70, v14
    v_accvgpr_read_b32 v15, a71
    v_mul_f32 v15, v15, v3
    v_accvgpr_write_b32 a71, v15
    v_accvgpr_read_b32 v8, a72
    v_mul_f32 v8, v8, v3
    v_accvgpr_write_b32 a72, v8
    v_accvgpr_read_b32 v9, a73
    v_mul_f32 v9, v9, v3
    v_accvgpr_write_b32 a73, v9
    v_accvgpr_read_b32 v10, a74
    v_mul_f32 v10, v10, v3
    v_accvgpr_write_b32 a74, v10
    v_accvgpr_read_b32 v11, a75
    v_mul_f32 v11, v11, v3
    v_accvgpr_write_b32 a75, v11
    v_accvgpr_read_b32 v12, a76
    v_mul_f32 v12, v12, v3
    v_accvgpr_write_b32 a76, v12
    v_accvgpr_read_b32 v13, a77
    v_mul_f32 v13, v13, v3
    v_accvgpr_write_b32 a77, v13
    v_accvgpr_read_b32 v14, a78
    v_mul_f32 v14, v14, v3
    v_accvgpr_write_b32 a78, v14
    v_accvgpr_read_b32 v15, a79
    v_mul_f32 v15, v15, v3
    v_accvgpr_write_b32 a79, v15
    v_accvgpr_read_b32 v8, a80
    v_mul_f32 v8, v8, v3
    v_accvgpr_write_b32 a80, v8
    v_accvgpr_read_b32 v9, a81
    v_mul_f32 v9, v9, v3
    v_accvgpr_write_b32 a81, v9
    v_accvgpr_read_b32 v10, a82
    v_mul_f32 v10, v10, v3
    v_accvgpr_write_b32 a82, v10
    v_accvgpr_read_b32 v11, a83
    v_mul_f32 v11, v11, v3
    v_accvgpr_write_b32 a83, v11
    v_accvgpr_read_b32 v12, a84
    v_mul_f32 v12, v12, v3
    v_accvgpr_write_b32 a84, v12
    v_accvgpr_read_b32 v13, a85
    v_mul_f32 v13, v13, v3
    v_accvgpr_write_b32 a85, v13
    v_accvgpr_read_b32 v14, a86
    v_mul_f32 v14, v14, v3
    v_accvgpr_write_b32 a86, v14
    v_accvgpr_read_b32 v15, a87
    v_mul_f32 v15, v15, v3
    v_accvgpr_write_b32 a87, v15
    v_accvgpr_read_b32 v8, a88
    v_mul_f32 v8, v8, v3
    v_accvgpr_write_b32 a88, v8
    v_accvgpr_read_b32 v9, a89
    v_mul_f32 v9, v9, v3
    v_accvgpr_write_b32 a89, v9
    v_accvgpr_read_b32 v10, a90
    v_mul_f32 v10, v10, v3
    v_accvgpr_write_b32 a90, v10
    v_accvgpr_read_b32 v11, a91
    v_mul_f32 v11, v11, v3
    v_accvgpr_write_b32 a91, v11
    v_accvgpr_read_b32 v12, a92
    v_mul_f32 v12, v12, v3
    v_accvgpr_write_b32 a92, v12
    v_accvgpr_read_b32 v13, a93
    v_mul_f32 v13, v13, v3
    v_accvgpr_write_b32 a93, v13
    v_accvgpr_read_b32 v14, a94
    v_mul_f32 v14, v14, v3
    v_accvgpr_write_b32 a94, v14
    v_accvgpr_read_b32 v15, a95
    v_mul_f32 v15, v15, v3
    v_accvgpr_write_b32 a95, v15
    v_accvgpr_read_b32 v8, a96
    v_mul_f32 v8, v8, v3
    v_accvgpr_write_b32 a96, v8
    v_accvgpr_read_b32 v9, a97
    v_mul_f32 v9, v9, v3
    v_accvgpr_write_b32 a97, v9
    v_accvgpr_read_b32 v10, a98
    v_mul_f32 v10, v10, v3
    v_accvgpr_write_b32 a98, v10
    v_accvgpr_read_b32 v11, a99
    v_mul_f32 v11, v11, v3
    v_accvgpr_write_b32 a99, v11
    v_accvgpr_read_b32 v12, a100
    v_mul_f32 v12, v12, v3
    v_accvgpr_write_b32 a100, v12
    v_accvgpr_read_b32 v13, a101
    v_mul_f32 v13, v13, v3
    v_accvgpr_write_b32 a101, v13
    v_accvgpr_read_b32 v14, a102
    v_mul_f32 v14, v14, v3
    v_accvgpr_write_b32 a102, v14
    v_accvgpr_read_b32 v15, a103
    v_mul_f32 v15, v15, v3
    v_accvgpr_write_b32 a103, v15
    v_accvgpr_read_b32 v8, a104
    v_mul_f32 v8, v8, v3
    v_accvgpr_write_b32 a104, v8
    v_accvgpr_read_b32 v9, a105
    v_mul_f32 v9, v9, v3
    v_accvgpr_write_b32 a105, v9
    v_accvgpr_read_b32 v10, a106
    v_mul_f32 v10, v10, v3
    v_accvgpr_write_b32 a106, v10
    v_accvgpr_read_b32 v11, a107
    v_mul_f32 v11, v11, v3
    v_accvgpr_write_b32 a107, v11
    v_accvgpr_read_b32 v12, a108
    v_mul_f32 v12, v12, v3
    v_accvgpr_write_b32 a108, v12
    v_accvgpr_read_b32 v13, a109
    v_mul_f32 v13, v13, v3
    v_accvgpr_write_b32 a109, v13
    v_accvgpr_read_b32 v14, a110
    v_mul_f32 v14, v14, v3
    v_accvgpr_write_b32 a110, v14
    v_accvgpr_read_b32 v15, a111
    v_mul_f32 v15, v15, v3
    v_accvgpr_write_b32 a111, v15
    v_accvgpr_read_b32 v8, a112
    v_mul_f32 v8, v8, v3
    v_accvgpr_write_b32 a112, v8
    v_accvgpr_read_b32 v9, a113
    v_mul_f32 v9, v9, v3
    v_accvgpr_write_b32 a113, v9
    v_accvgpr_read_b32 v10, a114
    v_mul_f32 v10, v10, v3
    v_accvgpr_write_b32 a114, v10
    v_accvgpr_read_b32 v11, a115
    v_mul_f32 v11, v11, v3
    v_accvgpr_write_b32 a115, v11
    v_accvgpr_read_b32 v12, a116
    v_mul_f32 v12, v12, v3
    v_accvgpr_write_b32 a116, v12
    v_accvgpr_read_b32 v13, a117
    v_mul_f32 v13, v13, v3
    v_accvgpr_write_b32 a117, v13
    v_accvgpr_read_b32 v14, a118
    v_mul_f32 v14, v14, v3
    v_accvgpr_write_b32 a118, v14
    v_accvgpr_read_b32 v15, a119
    v_mul_f32 v15, v15, v3
    v_accvgpr_write_b32 a119, v15
    v_accvgpr_read_b32 v8, a120
    v_mul_f32 v8, v8, v3
    v_accvgpr_write_b32 a120, v8
    v_accvgpr_read_b32 v9, a121
    v_mul_f32 v9, v9, v3
    v_accvgpr_write_b32 a121, v9
    v_accvgpr_read_b32 v10, a122
    v_mul_f32 v10, v10, v3
    v_accvgpr_write_b32 a122, v10
    v_accvgpr_read_b32 v11, a123
    v_mul_f32 v11, v11, v3
    v_accvgpr_write_b32 a123, v11
    v_accvgpr_read_b32 v12, a124
    v_mul_f32 v12, v12, v3
    v_accvgpr_write_b32 a124, v12
    v_accvgpr_read_b32 v13, a125
    v_mul_f32 v13, v13, v3
    v_accvgpr_write_b32 a125, v13
    v_accvgpr_read_b32 v14, a126
    v_mul_f32 v14, v14, v3
    v_accvgpr_write_b32 a126, v14
    v_accvgpr_read_b32 v15, a127
    v_mul_f32 v15, v15, v3
    v_accvgpr_write_b32 a127, v15
    v_max_f32 v252, v252, v218
    v_sub_f32 v4, v218, v252
    v_exp_f32 v4, v4
    v_mov_b32 v218, v252
    v_mul_f32 v221, v221, v4
    v_accvgpr_read_b32 v8, a128
    v_mul_f32 v8, v8, v4
    v_accvgpr_write_b32 a128, v8
    v_accvgpr_read_b32 v9, a129
    v_mul_f32 v9, v9, v4
    v_accvgpr_write_b32 a129, v9
    v_accvgpr_read_b32 v10, a130
    v_mul_f32 v10, v10, v4
    v_accvgpr_write_b32 a130, v10
    v_accvgpr_read_b32 v11, a131
    v_mul_f32 v11, v11, v4
    v_accvgpr_write_b32 a131, v11
    v_accvgpr_read_b32 v12, a132
    v_mul_f32 v12, v12, v4
    v_accvgpr_write_b32 a132, v12
    v_accvgpr_read_b32 v13, a133
    v_mul_f32 v13, v13, v4
    v_accvgpr_write_b32 a133, v13
    v_accvgpr_read_b32 v14, a134
    v_mul_f32 v14, v14, v4
    v_accvgpr_write_b32 a134, v14
    v_accvgpr_read_b32 v15, a135
    v_mul_f32 v15, v15, v4
    v_accvgpr_write_b32 a135, v15
    v_accvgpr_read_b32 v8, a136
    v_mul_f32 v8, v8, v4
    v_accvgpr_write_b32 a136, v8
    v_accvgpr_read_b32 v9, a137
    v_mul_f32 v9, v9, v4
    v_accvgpr_write_b32 a137, v9
    v_accvgpr_read_b32 v10, a138
    v_mul_f32 v10, v10, v4
    v_accvgpr_write_b32 a138, v10
    v_accvgpr_read_b32 v11, a139
    v_mul_f32 v11, v11, v4
    v_accvgpr_write_b32 a139, v11
    v_accvgpr_read_b32 v12, a140
    v_mul_f32 v12, v12, v4
    v_accvgpr_write_b32 a140, v12
    v_accvgpr_read_b32 v13, a141
    v_mul_f32 v13, v13, v4
    v_accvgpr_write_b32 a141, v13
    v_accvgpr_read_b32 v14, a142
    v_mul_f32 v14, v14, v4
    v_accvgpr_write_b32 a142, v14
    v_accvgpr_read_b32 v15, a143
    v_mul_f32 v15, v15, v4
    v_accvgpr_write_b32 a143, v15
    v_accvgpr_read_b32 v8, a144
    v_mul_f32 v8, v8, v4
    v_accvgpr_write_b32 a144, v8
    v_accvgpr_read_b32 v9, a145
    v_mul_f32 v9, v9, v4
    v_accvgpr_write_b32 a145, v9
    v_accvgpr_read_b32 v10, a146
    v_mul_f32 v10, v10, v4
    v_accvgpr_write_b32 a146, v10
    v_accvgpr_read_b32 v11, a147
    v_mul_f32 v11, v11, v4
    v_accvgpr_write_b32 a147, v11
    v_accvgpr_read_b32 v12, a148
    v_mul_f32 v12, v12, v4
    v_accvgpr_write_b32 a148, v12
    v_accvgpr_read_b32 v13, a149
    v_mul_f32 v13, v13, v4
    v_accvgpr_write_b32 a149, v13
    v_accvgpr_read_b32 v14, a150
    v_mul_f32 v14, v14, v4
    v_accvgpr_write_b32 a150, v14
    v_accvgpr_read_b32 v15, a151
    v_mul_f32 v15, v15, v4
    v_accvgpr_write_b32 a151, v15
    v_accvgpr_read_b32 v8, a152
    v_mul_f32 v8, v8, v4
    v_accvgpr_write_b32 a152, v8
    v_accvgpr_read_b32 v9, a153
    v_mul_f32 v9, v9, v4
    v_accvgpr_write_b32 a153, v9
    v_accvgpr_read_b32 v10, a154
    v_mul_f32 v10, v10, v4
    v_accvgpr_write_b32 a154, v10
    v_accvgpr_read_b32 v11, a155
    v_mul_f32 v11, v11, v4
    v_accvgpr_write_b32 a155, v11
    v_accvgpr_read_b32 v12, a156
    v_mul_f32 v12, v12, v4
    v_accvgpr_write_b32 a156, v12
    v_accvgpr_read_b32 v13, a157
    v_mul_f32 v13, v13, v4
    v_accvgpr_write_b32 a157, v13
    v_accvgpr_read_b32 v14, a158
    v_mul_f32 v14, v14, v4
    v_accvgpr_write_b32 a158, v14
    v_accvgpr_read_b32 v15, a159
    v_mul_f32 v15, v15, v4
    v_accvgpr_write_b32 a159, v15
    v_accvgpr_read_b32 v8, a160
    v_mul_f32 v8, v8, v4
    v_accvgpr_write_b32 a160, v8
    v_accvgpr_read_b32 v9, a161
    v_mul_f32 v9, v9, v4
    v_accvgpr_write_b32 a161, v9
    v_accvgpr_read_b32 v10, a162
    v_mul_f32 v10, v10, v4
    v_accvgpr_write_b32 a162, v10
    v_accvgpr_read_b32 v11, a163
    v_mul_f32 v11, v11, v4
    v_accvgpr_write_b32 a163, v11
    v_accvgpr_read_b32 v12, a164
    v_mul_f32 v12, v12, v4
    v_accvgpr_write_b32 a164, v12
    v_accvgpr_read_b32 v13, a165
    v_mul_f32 v13, v13, v4
    v_accvgpr_write_b32 a165, v13
    v_accvgpr_read_b32 v14, a166
    v_mul_f32 v14, v14, v4
    v_accvgpr_write_b32 a166, v14
    v_accvgpr_read_b32 v15, a167
    v_mul_f32 v15, v15, v4
    v_accvgpr_write_b32 a167, v15
    v_accvgpr_read_b32 v8, a168
    v_mul_f32 v8, v8, v4
    v_accvgpr_write_b32 a168, v8
    v_accvgpr_read_b32 v9, a169
    v_mul_f32 v9, v9, v4
    v_accvgpr_write_b32 a169, v9
    v_accvgpr_read_b32 v10, a170
    v_mul_f32 v10, v10, v4
    v_accvgpr_write_b32 a170, v10
    v_accvgpr_read_b32 v11, a171
    v_mul_f32 v11, v11, v4
    v_accvgpr_write_b32 a171, v11
    v_accvgpr_read_b32 v12, a172
    v_mul_f32 v12, v12, v4
    v_accvgpr_write_b32 a172, v12
    v_accvgpr_read_b32 v13, a173
    v_mul_f32 v13, v13, v4
    v_accvgpr_write_b32 a173, v13
    v_accvgpr_read_b32 v14, a174
    v_mul_f32 v14, v14, v4
    v_accvgpr_write_b32 a174, v14
    v_accvgpr_read_b32 v15, a175
    v_mul_f32 v15, v15, v4
    v_accvgpr_write_b32 a175, v15
    v_accvgpr_read_b32 v8, a176
    v_mul_f32 v8, v8, v4
    v_accvgpr_write_b32 a176, v8
    v_accvgpr_read_b32 v9, a177
    v_mul_f32 v9, v9, v4
    v_accvgpr_write_b32 a177, v9
    v_accvgpr_read_b32 v10, a178
    v_mul_f32 v10, v10, v4
    v_accvgpr_write_b32 a178, v10
    v_accvgpr_read_b32 v11, a179
    v_mul_f32 v11, v11, v4
    v_accvgpr_write_b32 a179, v11
    v_accvgpr_read_b32 v12, a180
    v_mul_f32 v12, v12, v4
    v_accvgpr_write_b32 a180, v12
    v_accvgpr_read_b32 v13, a181
    v_mul_f32 v13, v13, v4
    v_accvgpr_write_b32 a181, v13
    v_accvgpr_read_b32 v14, a182
    v_mul_f32 v14, v14, v4
    v_accvgpr_write_b32 a182, v14
    v_accvgpr_read_b32 v15, a183
    v_mul_f32 v15, v15, v4
    v_accvgpr_write_b32 a183, v15
    v_accvgpr_read_b32 v8, a184
    v_mul_f32 v8, v8, v4
    v_accvgpr_write_b32 a184, v8
    v_accvgpr_read_b32 v9, a185
    v_mul_f32 v9, v9, v4
    v_accvgpr_write_b32 a185, v9
    v_accvgpr_read_b32 v10, a186
    v_mul_f32 v10, v10, v4
    v_accvgpr_write_b32 a186, v10
    v_accvgpr_read_b32 v11, a187
    v_mul_f32 v11, v11, v4
    v_accvgpr_write_b32 a187, v11
    v_accvgpr_read_b32 v12, a188
    v_mul_f32 v12, v12, v4
    v_accvgpr_write_b32 a188, v12
    v_accvgpr_read_b32 v13, a189
    v_mul_f32 v13, v13, v4
    v_accvgpr_write_b32 a189, v13
    v_accvgpr_read_b32 v14, a190
    v_mul_f32 v14, v14, v4
    v_accvgpr_write_b32 a190, v14
    v_accvgpr_read_b32 v15, a191
    v_mul_f32 v15, v15, v4
    v_accvgpr_write_b32 a191, v15
    v_fma_f32 v184, v136, s21, -v216
    v_exp_f32 v184, v184
    v_fma_f32 v185, v137, s21, -v216
    v_exp_f32 v185, v185
    v_fma_f32 v186, v138, s21, -v216
    v_exp_f32 v186, v186
    v_fma_f32 v187, v139, s21, -v216
    v_exp_f32 v187, v187
    v_fma_f32 v188, v144, s21, -v217
    v_exp_f32 v188, v188
    v_fma_f32 v189, v145, s21, -v217
    v_exp_f32 v189, v189
    v_fma_f32 v190, v146, s21, -v217
    v_exp_f32 v190, v190
    v_fma_f32 v191, v147, s21, -v217
    v_exp_f32 v191, v191
    v_fma_f32 v192, v140, s21, -v216
    v_exp_f32 v192, v192
    v_fma_f32 v193, v141, s21, -v216
    v_exp_f32 v193, v193
    v_fma_f32 v194, v142, s21, -v216
    v_exp_f32 v194, v194
    v_fma_f32 v195, v143, s21, -v216
    v_exp_f32 v195, v195
    v_fma_f32 v196, v148, s21, -v217
    v_exp_f32 v196, v196
    v_fma_f32 v197, v149, s21, -v217
    v_exp_f32 v197, v197
    v_fma_f32 v198, v150, s21, -v217
    v_exp_f32 v198, v198
    v_fma_f32 v199, v151, s21, -v217
    v_exp_f32 v199, v199
    v_fma_f32 v242, v152, s21, -v218
    v_exp_f32 v242, v242
    v_fma_f32 v243, v153, s21, -v218
    v_exp_f32 v243, v243
    v_fma_f32 v244, v154, s21, -v218
    v_exp_f32 v244, v244
    v_fma_f32 v245, v155, s21, -v218
    v_exp_f32 v245, v245
    v_fma_f32 v246, v156, s21, -v218
    v_exp_f32 v246, v246
    v_fma_f32 v247, v157, s21, -v218
    v_exp_f32 v247, v247
    v_fma_f32 v248, v158, s21, -v218
    v_exp_f32 v248, v248
    v_fma_f32 v249, v159, s21, -v218
    v_exp_f32 v249, v249
    v_cvt_pk_bf16_f32 v172, v184, v185
    v_cvt_pk_bf16_f32 v173, v186, v187
    v_cvt_pk_bf16_f32 v176, v188, v189
    v_cvt_pk_bf16_f32 v177, v190, v191
    v_cvt_pk_bf16_f32 v174, v192, v193
    v_cvt_pk_bf16_f32 v175, v194, v195
    v_cvt_pk_bf16_f32 v178, v196, v197
    v_cvt_pk_bf16_f32 v179, v198, v199
    v_cvt_pk_bf16_f32 v180, v242, v243
    v_cvt_pk_bf16_f32 v181, v244, v245
    v_cvt_pk_bf16_f32 v182, v246, v247
    v_cvt_pk_bf16_f32 v183, v248, v249
    v_mfma_f32_16x16x32_bf16 v[200:203], v[212:215], v[172:175], 0
    v_mfma_f32_16x16x32_bf16 v[204:207], v[212:215], v[176:179], 0
    v_mfma_f32_16x16x32_bf16 v[208:211], v[212:215], v[180:183], 0
    s_nop 7
    s_nop 7
    s_setpc_b64 s[44:45]
.section .rodata,"a"
.p2align 6
.amdhsa_kernel standalone__mha_softmax__near_ridge_kernel
  .amdhsa_next_free_vgpr 512
  .amdhsa_next_free_sgpr 102
  .amdhsa_accum_offset 256
  .amdhsa_group_segment_fixed_size 0
  .amdhsa_kernarg_size 48
  .amdhsa_user_sgpr_count 2
  .amdhsa_user_sgpr_kernarg_segment_ptr 1
  .amdhsa_system_sgpr_workgroup_id_x 1
.end_amdhsa_kernel
```
